```python
import torch

def _softmax(x, axis=-1):
    return torch.softmax(x, dim=axis)
def _gelu(x):
    return torch.nn.functional.gelu(x, approximate="tanh")
def _silu(x):
    return torch.nn.functional.silu(x)
def _sigmoid(x):
    return torch.sigmoid(x)
def _layernorm(x, axis=-1, eps=1e-5):
    m = x.mean(dim=axis, keepdim=True)
    v = x.var(dim=axis, keepdim=True, unbiased=False)
    return (x - m) / torch.sqrt(v + eps)
def _scatter_add(tgt, idx, src, axis=0):
    return tgt.clone().index_add_(axis, idx, src)
def _segment_sum(src, seg, n):
    out = torch.zeros((n,) + src.shape[1:], dtype=src.dtype)
    return out.index_add_(0, seg, src)
def _pad(x, pw):
    flat = tuple(v for pair in reversed(pw) for v in pair)
    return torch.nn.functional.pad(x, flat)

kernel_name = 'gather_scatter__cheap_equivariant_egnn__graph'

def setup_inputs():

    _w = (lambda a: (lambda t: t.to(torch.bfloat16) if t.is_floating_point() else t)(torch.as_tensor(a)))
    N, deg, D, De = 10000, 16, 256, max(4, 1)
    E = N * deg
    return {
        "h": _w((lambda *s: torch.randn(*s, dtype=torch.bfloat16) * 0.2)(N, D)),
        "pos": _w((lambda *s: torch.randn(*s, dtype=torch.bfloat16) * 0.4)(N, 3)),
        "e_attr": _w((lambda *s: torch.randn(*s, dtype=torch.bfloat16) * 0.4)(E, De)),
        "src": _w((lambda lo, hi, *s: torch.randint(lo, hi, s))(0, N, E).to(torch.int64)),
        "dst": _w((lambda lo, hi, *s: torch.randint(lo, hi, s))(0, N, E).to(torch.int64)),
        "w_e": _w(0.1 * (lambda *s: torch.randn(*s, dtype=torch.bfloat16) * 0.4)(2 * D + 1 + De, D)),
        "w_x": _w(0.1 * (lambda *s: torch.randn(*s, dtype=torch.bfloat16) * 0.2)(D, 1)),
        "w_h": _w(0.1 * (lambda *s: torch.randn(*s, dtype=torch.bfloat16) * 0.2)(2 * D, D)),
    }

def reference(h, pos, e_attr, src, dst, w_e, w_x, w_h):
    N, D = h.shape[0], h.shape[1]
    diff = pos[dst] - pos[src]
    dist2 = torch.sum(diff * diff, axis=-1, keepdims=True)
    e_in = torch.concatenate([h[dst], h[src], dist2, e_attr], axis=-1)
    m_ij = _silu(e_in @ w_e)
    coord_scale = m_ij @ w_x
    pos_new = pos + _segment_sum(diff * coord_scale, dst, N)
    m_i = _segment_sum(m_ij, dst, N)
    h_new = h + _silu(torch.concatenate([h, m_i], axis=-1) @ w_h)
    return h_new, pos_new
```

```asm
; @launch grid=(256,1,1) block=(512,1,1) lds=161792
.amdgcn_target "amdgcn-amd-amdhsa--gfx950"
.text
.globl gather_scatter__cheap_equivariant_egnn__graph_kernel
.p2align 8
.type gather_scatter__cheap_equivariant_egnn__graph_kernel,@function
gather_scatter__cheap_equivariant_egnn__graph_kernel:
    s_cmp_ge_u32 s2, 256
    s_cbranch_scc1 K_END
    s_load_dwordx16 s[4:19], s[0:1], 0
    s_load_dwordx4 s[20:23], s[0:1], 64
    s_load_dwordx2 s[66:67], s[0:1], 80
    v_lshrrev_b32 v1, 6, v0
    s_nop 0
    v_readfirstlane_b32 s3, v1
    v_and_b32_e64 v1, 63, v0
    s_cmp_ge_u32 s2, 64
    s_cbranch_scc1 K_GP
    s_mul_i32 s80, s2, 2500
    v_add_u32 v3, s80, v0
    v_lshlrev_b32 v4, 3, v3
    v_lshlrev_b32 v3, 2, v3
    v_mov_b32 v60, 0
    v_mov_b32 v61, 0
    v_mov_b32 v62, 0
    v_mov_b32 v63, 0
    v_lshlrev_b32 v55, 4, v0
    s_movk_i32 s81, 0x1000
    s_movk_i32 s82, 0x2000
    s_movk_i32 s83, 0x3000
    s_movk_i32 s84, 0x4000
    v_cmp_gt_u32 vcc, 452, v0
    s_waitcnt lgkmcnt(0)
    s_mov_b64 s[60:61], vcc
    s_mov_b64 s[68:69], s[12:13]
    s_mov_b32 s70, 640000
    s_mov_b32 s71, 0x00020000
    buffer_load_dword v88, v3, s[68:71], 0 offen offset:0
    buffer_load_dword v89, v3, s[68:71], 0 offen offset:2048
    buffer_load_dword v90, v3, s[68:71], s81 offen offset:0
    buffer_load_dword v91, v3, s[68:71], s81 offen offset:2048
    buffer_load_dword v92, v3, s[68:71], s82 offen offset:0
    s_mov_b64 s[72:73], s[10:11]
    s_mov_b32 s74, 640000
    s_mov_b32 s75, 0x00020000
    s_mov_b64 s[76:77], s[8:9]
    s_mov_b32 s78, 1280000
    s_mov_b32 s79, 0x00020000
    s_mov_b64 s[32:33], s[4:5]
    s_mov_b32 s34, 5120000
    s_mov_b32 s35, 0x00020000
    s_mov_b64 s[24:25], s[66:67]
    s_mov_b32 s26, 8464640
    s_mov_b32 s27, 0x00020000
    v_cmp_gt_u32 vcc, 320, v0
    s_and_saveexec_b64 s[92:93], vcc
    ds_write_b128 v55, v[60:63] offset:23040
    s_mov_b64 exec, -1
    v_mov_b32 v56, 1
    v_mul_u32_u24_e64 v54, 20, v0
    v_add_u32 v54, 23040, v54
    s_waitcnt lgkmcnt(0)
    s_barrier
    buffer_load_dword v64, v3, s[72:75], 0 offen offset:0
    buffer_load_dword v65, v3, s[72:75], 0 offen offset:2048
    buffer_load_dword v66, v3, s[72:75], s81 offen offset:0
    buffer_load_dword v67, v3, s[72:75], s81 offen offset:2048
    buffer_load_dword v68, v3, s[72:75], s82 offen offset:0
    buffer_load_dwordx2 v[16:17], v4, s[76:79], 0 offen
    buffer_load_dwordx2 v[20:21], v4, s[76:79], s81 offen
    buffer_load_dwordx2 v[24:25], v4, s[76:79], s82 offen
    buffer_load_dwordx2 v[28:29], v4, s[76:79], s83 offen
    buffer_load_dwordx2 v[32:33], v4, s[76:79], s84 offen
    s_waitcnt vmcnt(14)
    v_and_b32 v52, 7, v88
    v_bfe_u32 v53, v88, 3, 5
    v_lshl_or_b32 v52, v52, 5, v53
    v_mul_u32_u24 v52, 20, v52
    v_lshrrev_b32 v53, 11, v88
    v_lshl_add_u32 v36, v53, 2, v52
    ds_add_rtn_u32 v42, v36, v56 offset:23040
    s_waitcnt vmcnt(13)
    v_and_b32 v52, 7, v89
    v_bfe_u32 v53, v89, 3, 5
    v_lshl_or_b32 v52, v52, 5, v53
    v_mul_u32_u24 v52, 20, v52
    v_lshrrev_b32 v53, 11, v89
    v_lshl_add_u32 v37, v53, 2, v52
    ds_add_rtn_u32 v43, v37, v56 offset:23040
    s_waitcnt vmcnt(12)
    v_and_b32 v52, 7, v90
    v_bfe_u32 v53, v90, 3, 5
    v_lshl_or_b32 v52, v52, 5, v53
    v_mul_u32_u24 v52, 20, v52
    v_lshrrev_b32 v53, 11, v90
    v_lshl_add_u32 v38, v53, 2, v52
    ds_add_rtn_u32 v44, v38, v56 offset:23040
    s_waitcnt vmcnt(11)
    v_and_b32 v52, 7, v91
    v_bfe_u32 v53, v91, 3, 5
    v_lshl_or_b32 v52, v52, 5, v53
    v_mul_u32_u24 v52, 20, v52
    v_lshrrev_b32 v53, 11, v91
    v_lshl_add_u32 v39, v53, 2, v52
    ds_add_rtn_u32 v45, v39, v56 offset:23040
    s_waitcnt vmcnt(10)
    v_and_b32 v52, 7, v92
    v_bfe_u32 v53, v92, 3, 5
    v_lshl_or_b32 v52, v52, 5, v53
    v_mul_u32_u24 v52, 20, v52
    v_lshrrev_b32 v53, 11, v92
    v_lshl_add_u32 v40, v53, 2, v52
    s_mov_b64 exec, s[60:61]
    ds_add_rtn_u32 v46, v40, v56 offset:23040
    s_mov_b64 exec, -1
    s_waitcnt lgkmcnt(0)
    s_barrier
    s_cmp_ge_u32 s3, 4
    s_cbranch_scc1 K_NOSCAN
    ds_read2_b32 v[72:73], v54 offset0:0 offset1:1
    ds_read2_b32 v[74:75], v54 offset0:2 offset1:3
    ds_read_b32 v76, v54 offset:16
    s_waitcnt lgkmcnt(0)
    v_add_u32 v73, v72, v73
    v_add_u32 v74, v73, v74
    v_add_u32 v75, v74, v75
    v_add_u32 v76, v75, v76
    v_mov_b32_e64 v70, v76
    s_nop 1
    v_add_u32_dpp v70, v70, v70 row_shr:1 row_mask:0xf bank_mask:0xf bound_ctrl:1
    s_nop 1
    v_add_u32_dpp v70, v70, v70 row_shr:2 row_mask:0xf bank_mask:0xf bound_ctrl:1
    s_nop 1
    v_add_u32_dpp v70, v70, v70 row_shr:4 row_mask:0xf bank_mask:0xf bound_ctrl:1
    s_nop 1
    v_add_u32_dpp v70, v70, v70 row_shr:8 row_mask:0xf bank_mask:0xf bound_ctrl:1
    s_nop 1
    v_add_u32_dpp v70, v70, v70 row_bcast:15 row_mask:0xa bank_mask:0xf
    s_nop 1
    v_add_u32_dpp v70, v70, v70 row_bcast:31 row_mask:0xc bank_mask:0xf
    s_lshl_b32 s56, s3, 2
    v_mov_b32 v52, s56
    s_mov_b32 exec_lo, 0
    s_mov_b32 exec_hi, 0x80000000
    ds_write_b32 v52, v70 offset:28160
    s_mov_b64 exec, -1
    v_sub_u32 v70, v70, v76
    s_waitcnt lgkmcnt(0)
    s_barrier
    ds_read_b128 v[80:83], v60 offset:28160
    s_waitcnt lgkmcnt(0)
    v_readfirstlane_b32 s56, v80
    v_readfirstlane_b32 s57, v81
    v_readfirstlane_b32 s58, v82
    s_nop 1
    s_cmp_ge_u32 s3, 1
    s_cselect_b32 s56, s56, 0
    s_cmp_ge_u32 s3, 2
    s_cselect_b32 s57, s57, 0
    s_cmp_ge_u32 s3, 3
    s_cselect_b32 s58, s58, 0
    s_add_u32 s56, s56, s57
    s_add_u32 s56, s56, s58
    v_add_u32 v70, s56, v70
    v_add_u32 v72, v70, v72
    v_add_u32 v73, v70, v73
    v_add_u32 v74, v70, v74
    v_add_u32 v75, v70, v75
    v_add_u32_e64 v76, v70, v76
    ds_write2_b32 v54, v70, v72 offset0:0 offset1:1
    ds_write2_b32 v54, v73, v74 offset0:2 offset1:3
    ds_write_b32 v54, v75 offset:16
    v_lshl_or_b32 v80, v72, 16, v70
    v_lshl_or_b32 v81, v74, 16, v73
    v_lshl_or_b32 v82, v76, 16, v75
    v_mov_b32 v83, 0
    s_branch K_SCANNED
K_NOSCAN:
    s_barrier
K_SCANNED:
    s_waitcnt vmcnt(5)
    v_lshrrev_b32_e64 v52, 8, v88
    v_lshl_or_b32 v18, v52, 16, v64
    v_and_b32_e64 v52, 3, v52
    v_lshl_or_b32 v18, v52, 23, v18
    v_bfe_u32 v52, v88, 10, 1
    v_lshl_or_b32 v18, v52, 31, v18
    v_mul_u32_u24 v52, 6, v64
    v_and_b32 v19, -4, v52
    v_lshrrev_b32_e64 v52, 8, v89
    v_lshl_or_b32 v22, v52, 16, v65
    v_and_b32_e64 v52, 3, v52
    v_lshl_or_b32 v22, v52, 23, v22
    v_bfe_u32 v52, v89, 10, 1
    v_lshl_or_b32 v22, v52, 31, v22
    v_mul_u32_u24 v52, 6, v65
    v_and_b32 v23, -4, v52
    v_lshrrev_b32_e64 v52, 8, v90
    v_lshl_or_b32 v26, v52, 16, v66
    v_and_b32_e64 v52, 3, v52
    v_lshl_or_b32 v26, v52, 23, v26
    v_bfe_u32 v52, v90, 10, 1
    v_lshl_or_b32 v26, v52, 31, v26
    v_mul_u32_u24 v52, 6, v66
    v_and_b32 v27, -4, v52
    v_lshrrev_b32_e64 v52, 8, v91
    v_lshl_or_b32 v30, v52, 16, v67
    v_and_b32_e64 v52, 3, v52
    v_lshl_or_b32 v30, v52, 23, v30
    v_bfe_u32 v52, v91, 10, 1
    v_lshl_or_b32 v30, v52, 31, v30
    v_mul_u32_u24 v52, 6, v67
    v_and_b32 v31, -4, v52
    v_lshrrev_b32_e64 v52, 8, v92
    v_lshl_or_b32 v34, v52, 16, v68
    v_and_b32_e64 v52, 3, v52
    v_lshl_or_b32 v34, v52, 23, v34
    v_bfe_u32 v52, v92, 10, 1
    v_lshl_or_b32 v34, v52, 31, v34
    v_mul_u32_u24 v52, 6, v68
    v_and_b32 v35, -4, v52
    s_waitcnt lgkmcnt(0)
    s_barrier
    ds_read_b32 v36, v36 offset:23040
    ds_read_b32 v37, v37 offset:23040
    ds_read_b32 v38, v38 offset:23040
    ds_read_b32 v39, v39 offset:23040
    ds_read_b32 v40, v40 offset:23040
    s_waitcnt vmcnt(0)
    s_cmp_ge_u32 s3, 4
    s_cbranch_scc1 K_NOOFF
    v_lshlrev_b32_e64 v52, 10, v0
    s_lshl_b32 s56, s2, 4
    s_add_u32 s56, s56, 5636096
    buffer_store_dwordx4 v[80:83], v52, s[24:27], s56 offen sc1
K_NOOFF:
    s_waitcnt lgkmcnt(0)
    v_add_u32 v52, v36, v42
    v_lshlrev_b32 v36, 4, v52
    v_add_u32 v52, v37, v43
    v_lshlrev_b32 v37, 4, v52
    v_add_u32 v52, v38, v44
    v_lshlrev_b32 v38, 4, v52
    v_add_u32 v52, v39, v45
    v_lshlrev_b32 v39, 4, v52
    v_add_u32 v52, v40, v46
    v_lshlrev_b32_e64 v40, 4, v52
    ds_write_b128 v36, v[16:19] offset:28416
    ds_write_b128 v37, v[20:23] offset:28416
    ds_write_b128 v38, v[24:27] offset:28416
    ds_write_b128 v39, v[28:31] offset:28416
    s_mov_b64 exec, s[60:61]
    ds_write_b128 v40, v[32:35] offset:28416
    s_mov_b64 exec, -1
    s_mul_i32 s56, s2, 40064
    s_add_u32 s56, s56, 5898240
    v_cmp_gt_u32 vcc, 456, v0
    s_waitcnt lgkmcnt(0)
    s_barrier
    ds_read_b128 v[16:19], v55 offset:28416
    ds_read_b128 v[20:23], v55 offset:36608
    ds_read_b128 v[24:27], v55 offset:44800
    ds_read_b128 v[28:31], v55 offset:52992
    ds_read_b128 v[32:35], v55 offset:61184
    s_waitcnt lgkmcnt(4)
    buffer_store_dwordx4 v[16:19], v55, s[24:27], s56 offen sc1
    s_add_u32 s56, s56, 8192
    s_waitcnt lgkmcnt(3)
    buffer_store_dwordx4 v[20:23], v55, s[24:27], s56 offen sc1
    s_add_u32 s56, s56, 8192
    s_waitcnt lgkmcnt(2)
    buffer_store_dwordx4 v[24:27], v55, s[24:27], s56 offen sc1
    s_add_u32 s56, s56, 8192
    s_waitcnt lgkmcnt(1)
    buffer_store_dwordx4 v[28:31], v55, s[24:27], s56 offen sc1
    s_add_u32 s56, s56, 8192
    s_waitcnt lgkmcnt(0)
    s_mov_b64 exec, vcc
    buffer_store_dwordx4 v[32:35], v55, s[24:27], s56 offen sc1
    s_add_u32 s56, s56, 8192
    s_mov_b64 exec, -1
    s_mov_b32 s80, 0
    s_mov_b32 s81, 63
K_ARRIVE:
    s_mov_b32 s62, 0
    v_mov_b32 v15, 0x80
    s_call_b64 s[90:91], K_SETA
    s_mov_b64 s[8:9], s[22:23]
    s_mov_b32 s10, 256
    s_mov_b32 s11, 0x00020000
    s_waitcnt vmcnt(0)
    s_barrier
    s_cmp_lg_u32 s3, 0
    s_cbranch_scc1 K_ARRD
    s_mov_b32 s82, 1
    s_atomic_add s82, s[8:9], s80 glc
    s_add_u32 s80, s80, 0x80
    s_waitcnt lgkmcnt(0)
    s_cmp_lg_u32 s82, s81
    s_cbranch_scc1 K_ARRD
    s_mov_b32 s82, 1
    s_atomic_add s82, s[8:9], s80
K_ARRD:
    v_and_b32 v10, 31, v1
    v_lshlrev_b32 v10, 4, v10
    v_lshrrev_b32 v11, 5, v1
    v_lshl_add_u32 v10, v11, 19, v10
    s_lshr_b32 s92, s3, 2
    s_lshl_b32 s92, s92, 3
    s_and_b32 s93, s3, 3
    s_add_u32 s92, s92, s93
    s_lshl_b32 s92, s92, 17
    s_lshl_b32 s93, s2, 9
    s_add_u32 s92, s92, s93
    s_mul_i32 s93, s3, 1040
    s_add_u32 s93, s93, 0
    s_mov_b32 m0, s93
    s_add_u32 s94, s92, 2097152
    buffer_load_dwordx4 v10, s[32:35], s92 offen lds
    s_add_u32 m0, s93, 8320
    s_add_u32 s95, s93, 16640
    buffer_load_dwordx4 v10, s[32:35], s94 offen lds
    s_cmp_lt_u32 s3, 4
    s_cselect_b32 s95, s95, 102912
    s_mov_b32 m0, s95
    s_add_u32 s94, s92, 4194304
    buffer_load_dwordx4 v10, s[32:35], s94 offen lds
    s_call_b64 s[90:91], K_SETL
    s_branch K_P2
K_GP:
    v_lshrrev_b32 v77, 5, v1
    s_and_b32 s80, s3, 1
    s_lshl_b32 s80, s80, 1
    v_add_u32 v3, s80, v77
    v_lshlrev_b32 v3, 2, v3
    v_and_b32 v73, 31, v1
    v_xor_b32 v72, v73, v3
    v_lshlrev_b32_e64 v72, 4, v72
    v_lshl_add_u32 v72, v77, 9, v72
    v_lshlrev_b32 v73, 4, v73
    s_lshl_b32 s81, s3, 10
    s_add_u32 s82, s81, 30208
    s_sub_u32 s83, s2, 64
    s_cmp_ge_u32 s83, 179
    s_waitcnt lgkmcnt(0)
    s_cbranch_scc1 K_PACK
    s_add_u32 s68, s14, 131072
    s_addc_u32 s69, s15, 0
    s_mov_b32 s70, 131072
    s_mov_b32 s71, 0x00020000
    s_mov_b64 s[32:33], s[4:5]
    s_mov_b32 s34, 5120000
    s_mov_b32 s35, 0x00020000
    s_cmp_lg_u32 s3, 0
    s_cbranch_scc1 K_NOPF
    s_lshr_b32 s80, s2, 3
    s_and_b32 s80, s80, 15
    s_lshl_b32 s80, s80, 13
    v_lshlrev_b32_e64 v3, 7, v1
    buffer_load_dword v142, v3, s[68:71], s80 offen
K_NOPF:
    s_lshr_b32 s80, s3, 2
    s_lshl_b32 s80, s80, 3
    s_and_b32 s84, s3, 3
    s_add_u32 s80, s80, s84
    v_lshl_add_u32 v2, v77, 2, s80
    s_lshl_b32 s56, s2, 9
    v_lshl_add_u32 v80, v2, 17, v73
    v_add_u32 v80, s56, v80
    s_mul_i32 s84, s3, 1040
    s_add_u32 m0, s84, 0
    v_add_u32 v81, 2097152, v80
    buffer_load_dwordx4 v80, s[32:35], 0 offen lds
    s_add_u32 m0, s84, 8320
    v_add_u32 v82, 4194304, v80
    buffer_load_dwordx4 v81, s[32:35], 0 offen lds
    s_mul_i32 s56, s83, 18
    v_mov_b32 v83, -16
    s_cmp_lt_u32 s3, 4
    s_cbranch_scc1 K_H2
    v_subrev_u32 v3, 8, v2
    v_add_u32_e64 v3, s56, v3
    v_mul_u32_u24 v4, 13618, v3
    v_lshrrev_b32_e64 v4, 20, v4
    v_mul_u32_u24 v5, 77, v4
    v_sub_u32 v5, v3, v5
    v_cmp_lt_u32 vcc, 63, v5
    v_lshl_add_u32 v4, v4, 8, v5
    v_add_u32 v5, 179, v4
    v_cndmask_b32_e64 v4, v4, v5, vcc
    v_lshl_add_u32 v82, v4, 9, v73
K_H2:
    s_add_u32 m0, s84, 16640
    s_cmp_gt_u32 s3, 4
    buffer_load_dwordx4 v82, s[32:35], 0 offen lds
    s_cbranch_scc1 K_H3
    v_add_u32 v3, 8, v2
    v_min_u32 v3, 17, v3
    v_add_u32_e64 v3, s56, v3
    v_mul_u32_u24 v4, 13618, v3
    v_lshrrev_b32_e64 v4, 20, v4
    v_mul_u32_u24 v5, 77, v4
    v_sub_u32 v5, v3, v5
    v_cmp_lt_u32 vcc, 63, v5
    v_lshl_add_u32 v4, v4, 8, v5
    v_add_u32 v5, 179, v4
    v_cndmask_b32_e64 v4, v4, v5, vcc
    v_lshl_add_u32 v83, v4, 9, v73
    s_add_u32 m0, s84, 24960
    s_nop 0
    buffer_load_dwordx4 v83, s[32:35], 0 offen lds
K_H3:
    s_add_u32 m0, s82, 0
    s_add_u32 s56, s81, 0
    buffer_load_dwordx4 v72, s[68:71], s56 offen lds
    s_cmp_ge_u32 s2, 128
    s_cbranch_scc1 K_NOTOUCH
    s_getpc_b64 s[92:93]
K_PC:
    s_sub_u32 s92, s92, K_PC-gather_scatter__cheap_equivariant_egnn__graph_kernel
    s_subb_u32 s93, s93, 0
    s_and_b32 s94, s2, 56
    s_add_u32 s94, s94, s3
    s_lshl_b32 s94, s94, 6
    s_add_u32 s95, s94, 0
    s_min_u32 s95, s95, K_END-gather_scatter__cheap_equivariant_egnn__graph_kernel
    s_load_dword s79, s[92:93], s95
    s_add_u32 s95, s94, 4096
    s_min_u32 s95, s95, K_END-gather_scatter__cheap_equivariant_egnn__graph_kernel
    s_load_dword s79, s[92:93], s95
    s_add_u32 s95, s94, 8192
    s_min_u32 s95, s95, K_END-gather_scatter__cheap_equivariant_egnn__graph_kernel
    s_load_dword s79, s[92:93], s95
    s_add_u32 s95, s94, 12288
    s_min_u32 s95, s95, K_END-gather_scatter__cheap_equivariant_egnn__graph_kernel
    s_load_dword s79, s[92:93], s95
    s_add_u32 s95, s94, 16384
    s_min_u32 s95, s95, K_END-gather_scatter__cheap_equivariant_egnn__graph_kernel
    s_load_dword s79, s[92:93], s95
K_NOTOUCH:
    v_mul_u32_u24 v79, 528, v2
    v_add_u32_e64 v79, v73, v79
    s_add_u32 m0, s82, 8192
    s_add_u32 s56, s81, 8192
    buffer_load_dwordx4 v72, s[68:71], s56 offen lds
    s_add_u32 m0, s82, 16384
    s_add_u32 s56, s81, 16384
    buffer_load_dwordx4 v72, s[68:71], s56 offen lds
    s_add_u32 m0, s82, 24576
    s_add_u32 s56, s81, 24576
    buffer_load_dwordx4 v72, s[68:71], s56 offen lds
    v_bfe_u32 v3, v1, 2, 2
    v_lshl_add_u32 v4, v77, 3, v3
    v_lshlrev_b32 v75, 9, v4
    v_xor_b32 v3, s3, v3
    v_lshl_add_u32 v75, v3, 6, v75
    v_bfe_u32 v3, v1, 4, 1
    v_lshl_add_u32 v75, v3, 5, v75
    v_and_b32_e64 v3, 3, v1
    v_lshl_add_u32 v75, v3, 3, v75
    v_add_u32 v75, 30208, v75
    v_add_u32 v76, 0x10000, v75
    v_and_b32_e64 v3, 31, v1
    v_mul_u32_u24 v78, 528, v3
    v_lshl_add_u32 v78, v77, 3, v78
    s_lshl_b32 s84, s3, 6
    v_add_u32 v78, s84, v78
    v_and_b32_e64 v3, 3, v1
    v_bfe_u32 v4, v1, 3, 2
    v_lshl_add_u32 v3, v4, 2, v3
    v_mul_u32_u24 v74, 1040, v3
    v_bfe_u32 v4, v1, 2, 1
    v_lshl_add_u32 v74, v4, 9, v74
    v_lshl_add_u32 v74, v77, 4, v74
    s_mov_b32 s96, 0xbfb8aa3b
    s_mov_b32 s97, 0xbfb8aa3b
    s_mov_b32 s62, 1
    s_mov_b64 s[72:73], s[66:67]
    s_mov_b32 s74, 5120000
    s_mov_b32 s75, 0x00020000
    s_mov_b64 s[8:9], s[22:23]
    s_mov_b32 s10, 256
    s_mov_b32 s11, 0x00020000
    v_mov_b32 v15, 0x80
    s_add_u32 m0, s82, 32768
    s_add_u32 s56, s81, 32768
    buffer_load_dwordx4 v72, s[68:71], s56 offen lds
    s_add_u32 m0, s82, 40960
    s_add_u32 s56, s81, 40960
    buffer_load_dwordx4 v72, s[68:71], s56 offen lds
    s_add_u32 m0, s82, 49152
    s_add_u32 s56, s81, 49152
    buffer_load_dwordx4 v72, s[68:71], s56 offen lds
    s_add_u32 m0, s82, 57344
    s_add_u32 s56, s81, 57344
    buffer_load_dwordx4 v72, s[68:71], s56 offen lds
    s_waitcnt vmcnt(4)
    s_barrier
    ds_read_b64_tr_b16 v[64:65], v75 offset:0
    ds_read_b64_tr_b16 v[66:67], v75 offset:2048
    ds_read_b128 v[48:51], v74 offset:0
    ds_read_b128 v[52:55], v74 offset:16640
    ds_read_b64_tr_b16 v[68:69], v75 offset:8192
    ds_read_b64_tr_b16 v[70:71], v75 offset:10240
    ds_read_b128 v[56:59], v74 offset:32
    ds_read_b128 v[60:63], v74 offset:16672
    ds_read_b64_tr_b16 v[112:113], v75 offset:16384
    ds_read_b64_tr_b16 v[114:115], v75 offset:18432
    ds_read_b128 v[96:99], v74 offset:64
    ds_read_b128 v[100:103], v74 offset:16704
    s_waitcnt lgkmcnt(8)
    v_mfma_f32_32x32x16_bf16 v[16:31], v[64:67], v[48:51], 0
    v_mfma_f32_32x32x16_bf16 v[32:47], v[64:67], v[52:55], 0
    ds_read_b64_tr_b16 v[64:65], v75 offset:24576
    ds_read_b64_tr_b16 v[66:67], v75 offset:26624
    ds_read_b128 v[48:51], v74 offset:96
    ds_read_b128 v[52:55], v74 offset:16736
    s_waitcnt lgkmcnt(8)
    v_mfma_f32_32x32x16_bf16 v[16:31], v[68:71], v[56:59], v[16:31]
    v_mfma_f32_32x32x16_bf16 v[32:47], v[68:71], v[60:63], v[32:47]
    s_add_u32 m0, s82, 65536
    s_add_u32 s56, s81, 65536
    buffer_load_dwordx4 v72, s[68:71], s56 offen lds
    s_add_u32 m0, s82, 73728
    s_add_u32 s56, s81, 73728
    buffer_load_dwordx4 v72, s[68:71], s56 offen lds
    s_add_u32 m0, s82, 81920
    s_add_u32 s56, s81, 81920
    buffer_load_dwordx4 v72, s[68:71], s56 offen lds
    s_add_u32 m0, s82, 90112
    s_add_u32 s56, s81, 90112
    buffer_load_dwordx4 v72, s[68:71], s56 offen lds
    s_waitcnt vmcnt(4)
    s_barrier
    ds_read_b64_tr_b16 v[68:69], v75 offset:32768
    ds_read_b64_tr_b16 v[70:71], v75 offset:34816
    ds_read_b128 v[56:59], v74 offset:128
    ds_read_b128 v[60:63], v74 offset:16768
    s_waitcnt lgkmcnt(8)
    v_mfma_f32_32x32x16_bf16 v[16:31], v[112:115], v[96:99], v[16:31]
    v_mfma_f32_32x32x16_bf16 v[32:47], v[112:115], v[100:103], v[32:47]
    ds_read_b64_tr_b16 v[112:113], v75 offset:40960
    ds_read_b64_tr_b16 v[114:115], v75 offset:43008
    ds_read_b128 v[96:99], v74 offset:160
    ds_read_b128 v[100:103], v74 offset:16800
    s_waitcnt lgkmcnt(8)
    v_mfma_f32_32x32x16_bf16 v[16:31], v[64:67], v[48:51], v[16:31]
    v_mfma_f32_32x32x16_bf16 v[32:47], v[64:67], v[52:55], v[32:47]
    ds_read_b64_tr_b16 v[64:65], v75 offset:49152
    ds_read_b64_tr_b16 v[66:67], v75 offset:51200
    ds_read_b128 v[48:51], v74 offset:192
    ds_read_b128 v[52:55], v74 offset:16832
    s_waitcnt lgkmcnt(8)
    v_mfma_f32_32x32x16_bf16 v[16:31], v[68:71], v[56:59], v[16:31]
    v_mfma_f32_32x32x16_bf16 v[32:47], v[68:71], v[60:63], v[32:47]
    ds_read_b64_tr_b16 v[68:69], v75 offset:57344
    ds_read_b64_tr_b16 v[70:71], v75 offset:59392
    ds_read_b128 v[56:59], v74 offset:224
    ds_read_b128 v[60:63], v74 offset:16864
    s_waitcnt lgkmcnt(8)
    v_mfma_f32_32x32x16_bf16 v[16:31], v[112:115], v[96:99], v[16:31]
    v_mfma_f32_32x32x16_bf16 v[32:47], v[112:115], v[100:103], v[32:47]
    s_add_u32 m0, s82, 98304
    s_add_u32 s56, s81, 98304
    buffer_load_dwordx4 v72, s[68:71], s56 offen lds
    s_add_u32 m0, s82, 106496
    s_add_u32 s56, s81, 106496
    buffer_load_dwordx4 v72, s[68:71], s56 offen lds
    s_add_u32 m0, s82, 114688
    s_add_u32 s56, s81, 114688
    buffer_load_dwordx4 v72, s[68:71], s56 offen lds
    s_add_u32 m0, s82, 122880
    s_add_u32 s56, s81, 122880
    buffer_load_dwordx4 v72, s[68:71], s56 offen lds
    s_waitcnt vmcnt(4)
    s_barrier
    ds_read_b64_tr_b16 v[112:113], v76 offset:0
    ds_read_b64_tr_b16 v[114:115], v76 offset:2048
    ds_read_b128 v[96:99], v74 offset:256
    ds_read_b128 v[100:103], v74 offset:16896
    s_waitcnt lgkmcnt(8)
    v_mfma_f32_32x32x16_bf16 v[16:31], v[64:67], v[48:51], v[16:31]
    v_mfma_f32_32x32x16_bf16 v[32:47], v[64:67], v[52:55], v[32:47]
    ds_read_b64_tr_b16 v[64:65], v76 offset:8192
    ds_read_b64_tr_b16 v[66:67], v76 offset:10240
    ds_read_b128 v[48:51], v74 offset:288
    ds_read_b128 v[52:55], v74 offset:16928
    s_waitcnt lgkmcnt(8)
    v_mfma_f32_32x32x16_bf16 v[16:31], v[68:71], v[56:59], v[16:31]
    v_mfma_f32_32x32x16_bf16 v[32:47], v[68:71], v[60:63], v[32:47]
    ds_read_b64_tr_b16 v[68:69], v76 offset:16384
    ds_read_b64_tr_b16 v[70:71], v76 offset:18432
    ds_read_b128 v[56:59], v74 offset:320
    ds_read_b128 v[60:63], v74 offset:16960
    s_waitcnt lgkmcnt(8)
    v_mfma_f32_32x32x16_bf16 v[16:31], v[112:115], v[96:99], v[16:31]
    v_mfma_f32_32x32x16_bf16 v[32:47], v[112:115], v[100:103], v[32:47]
    ds_read_b64_tr_b16 v[112:113], v76 offset:24576
    ds_read_b64_tr_b16 v[114:115], v76 offset:26624
    ds_read_b128 v[96:99], v74 offset:352
    ds_read_b128 v[100:103], v74 offset:16992
    s_waitcnt lgkmcnt(8)
    v_mfma_f32_32x32x16_bf16 v[16:31], v[64:67], v[48:51], v[16:31]
    v_mfma_f32_32x32x16_bf16 v[32:47], v[64:67], v[52:55], v[32:47]
    s_waitcnt vmcnt(0)
    s_barrier
    ds_read_b64_tr_b16 v[64:65], v76 offset:32768
    ds_read_b64_tr_b16 v[66:67], v76 offset:34816
    ds_read_b128 v[48:51], v74 offset:384
    ds_read_b128 v[52:55], v74 offset:17024
    s_waitcnt lgkmcnt(8)
    v_mfma_f32_32x32x16_bf16 v[16:31], v[68:71], v[56:59], v[16:31]
    v_mfma_f32_32x32x16_bf16 v[32:47], v[68:71], v[60:63], v[32:47]
    ds_read_b64_tr_b16 v[68:69], v76 offset:40960
    ds_read_b64_tr_b16 v[70:71], v76 offset:43008
    ds_read_b128 v[56:59], v74 offset:416
    ds_read_b128 v[60:63], v74 offset:17056
    s_waitcnt lgkmcnt(8)
    v_mfma_f32_32x32x16_bf16 v[16:31], v[112:115], v[96:99], v[16:31]
    v_mfma_f32_32x32x16_bf16 v[32:47], v[112:115], v[100:103], v[32:47]
    ds_read_b64_tr_b16 v[112:113], v76 offset:49152
    ds_read_b64_tr_b16 v[114:115], v76 offset:51200
    ds_read_b128 v[96:99], v74 offset:448
    ds_read_b128 v[100:103], v74 offset:17088
    s_waitcnt lgkmcnt(8)
    v_mfma_f32_32x32x16_bf16 v[16:31], v[64:67], v[48:51], v[16:31]
    v_mfma_f32_32x32x16_bf16 v[32:47], v[64:67], v[52:55], v[32:47]
    ds_read_b64_tr_b16 v[64:65], v76 offset:57344
    ds_read_b64_tr_b16 v[66:67], v76 offset:59392
    ds_read_b128 v[48:51], v74 offset:480
    ds_read_b128 v[52:55], v74 offset:17120
    s_waitcnt lgkmcnt(8)
    v_mfma_f32_32x32x16_bf16 v[16:31], v[68:71], v[56:59], v[16:31]
    v_mfma_f32_32x32x16_bf16 v[32:47], v[68:71], v[60:63], v[32:47]
    s_waitcnt lgkmcnt(4)
    v_mfma_f32_32x32x16_bf16 v[16:31], v[112:115], v[96:99], v[16:31]
    v_mfma_f32_32x32x16_bf16 v[32:47], v[112:115], v[100:103], v[32:47]
    s_waitcnt lgkmcnt(0)
    v_mfma_f32_32x32x16_bf16 v[16:31], v[64:67], v[48:51], v[16:31]
    v_mfma_f32_32x32x16_bf16 v[32:47], v[64:67], v[52:55], v[32:47]
    s_call_b64 s[90:91], K_SETL
    s_barrier
    v_pk_mul_f32 v[16:17], v[16:17], s[96:97]
    v_pk_mul_f32 v[18:19], v[18:19], s[96:97]
    v_cvt_pk_bf16_f32 v48, v16, v17
    v_cvt_pk_bf16_f32 v49, v18, v19
    ds_write_b64 v78, v[48:49] offset:30208
    v_pk_mul_f32 v[20:21], v[20:21], s[96:97]
    v_pk_mul_f32 v[22:23], v[22:23], s[96:97]
    v_cvt_pk_bf16_f32 v50, v20, v21
    v_cvt_pk_bf16_f32 v51, v22, v23
    ds_write_b64 v78, v[50:51] offset:30224
    v_pk_mul_f32 v[24:25], v[24:25], s[96:97]
    v_pk_mul_f32 v[26:27], v[26:27], s[96:97]
    v_cvt_pk_bf16_f32 v52, v24, v25
    v_cvt_pk_bf16_f32 v53, v26, v27
    ds_write_b64 v78, v[52:53] offset:30240
    v_pk_mul_f32 v[28:29], v[28:29], s[96:97]
    v_pk_mul_f32 v[30:31], v[30:31], s[96:97]
    v_cvt_pk_bf16_f32 v54, v28, v29
    v_cvt_pk_bf16_f32 v55, v30, v31
    ds_write_b64 v78, v[54:55] offset:30256
    v_pk_mul_f32 v[32:33], v[32:33], s[96:97]
    v_pk_mul_f32 v[34:35], v[34:35], s[96:97]
    v_cvt_pk_bf16_f32 v56, v32, v33
    v_cvt_pk_bf16_f32 v57, v34, v35
    ds_write_b64 v78, v[56:57] offset:47104
    v_pk_mul_f32 v[36:37], v[36:37], s[96:97]
    v_pk_mul_f32 v[38:39], v[38:39], s[96:97]
    v_cvt_pk_bf16_f32 v58, v36, v37
    v_cvt_pk_bf16_f32 v59, v38, v39
    ds_write_b64 v78, v[58:59] offset:47120
    v_pk_mul_f32 v[40:41], v[40:41], s[96:97]
    v_pk_mul_f32 v[42:43], v[42:43], s[96:97]
    v_cvt_pk_bf16_f32 v60, v40, v41
    v_cvt_pk_bf16_f32 v61, v42, v43
    ds_write_b64 v78, v[60:61] offset:47136
    v_pk_mul_f32 v[44:45], v[44:45], s[96:97]
    v_pk_mul_f32 v[46:47], v[46:47], s[96:97]
    v_cvt_pk_bf16_f32 v62, v44, v45
    v_cvt_pk_bf16_f32 v63, v46, v47
    ds_write_b64 v78, v[62:63] offset:47152
    s_waitcnt lgkmcnt(0)
    s_barrier
    ds_read_b128 v[16:19], v79 offset:30208
    ds_read_b128 v[20:23], v79 offset:38656
    ds_read_b128 v[24:27], v79 offset:47104
    ds_read_b128 v[28:31], v79 offset:55552
    s_waitcnt lgkmcnt(3)
    buffer_store_dwordx4 v[16:19], v80, s[72:75], 0 offen sc1
    s_waitcnt lgkmcnt(2)
    buffer_store_dwordx4 v[20:23], v81, s[72:75], 0 offen sc1
    s_waitcnt lgkmcnt(1)
    buffer_store_dwordx4 v[24:27], v82, s[72:75], 0 offen sc1
    s_cmp_gt_u32 s3, 4
    s_cbranch_scc1 K_ST3
    s_waitcnt lgkmcnt(0)
    buffer_store_dwordx4 v[28:31], v83, s[72:75], 0 offen sc1
K_ST3:
    s_branch K_P2
K_PACK:
    s_mov_b64 s[32:33], s[4:5]
    s_mov_b32 s34, 5120000
    s_mov_b32 s35, 0x00020000
    s_mov_b64 s[24:25], s[66:67]
    s_mov_b32 s26, 8464640
    s_mov_b32 s27, 0x00020000
    s_sub_u32 s83, s83, 179
    s_cmp_ge_u32 s83, 12
    s_cbranch_scc1 K_IDLE
    s_lshr_b32 s84, s83, 2
    s_and_b32 s83, s83, 3
    s_mov_b32 s68, s14
    s_mov_b32 s69, s15
    s_cmp_eq_u32 s84, 0
    s_cbranch_scc1 K_WSEL
    s_mov_b32 s68, s18
    s_mov_b32 s69, s19
    s_cmp_eq_u32 s84, 1
    s_cbranch_scc1 K_WSEL
    s_add_u32 s68, s18, 131072
    s_addc_u32 s69, s19, 0
K_WSEL:
    s_mov_b32 s70, 131072
    s_mov_b32 s71, 0x00020000
    s_lshl_b32 s80, s83, 15
    s_add_u32 s81, s81, s80
    s_add_u32 m0, s82, 0
    s_add_u32 s56, s81, 0
    buffer_load_dwordx4 v72, s[68:71], s56 offen lds
    s_add_u32 m0, s82, 8192
    s_add_u32 s56, s81, 8192
    buffer_load_dwordx4 v72, s[68:71], s56 offen lds
    s_add_u32 m0, s82, 16384
    s_add_u32 s56, s81, 16384
    buffer_load_dwordx4 v72, s[68:71], s56 offen lds
    s_add_u32 m0, s82, 24576
    s_add_u32 s56, s81, 24576
    buffer_load_dwordx4 v72, s[68:71], s56 offen lds
    v_bfe_u32 v3, v1, 2, 2
    v_lshl_add_u32 v4, v77, 3, v3
    v_lshlrev_b32 v75, 9, v4
    v_xor_b32_e64 v3, s3, v3
    v_lshl_add_u32 v75, v3, 6, v75
    v_bfe_u32 v3, v1, 4, 1
    v_lshl_add_u32 v75, v3, 5, v75
    v_and_b32_e64 v3, 3, v1
    v_lshl_add_u32 v75, v3, 3, v75
    v_add_u32 v75, 30208, v75
    s_lshl_b32 s84, s84, 17
    s_lshl_b32 s80, s83, 12
    s_add_u32 s84, s84, s80
    s_lshl_b32 s80, s3, 14
    s_add_u32 s84, s84, s80
    s_add_u32 s84, s84, 5242880
    v_lshlrev_b32 v3, 4, v1
    s_waitcnt vmcnt(0)
    s_barrier
    ds_read_b64_tr_b16 v[16:17], v75 offset:0
    ds_read_b64_tr_b16 v[18:19], v75 offset:2048
    ds_read_b64_tr_b16 v[20:21], v75 offset:8192
    ds_read_b64_tr_b16 v[22:23], v75 offset:10240
    ds_read_b64_tr_b16 v[24:25], v75 offset:16384
    ds_read_b64_tr_b16 v[26:27], v75 offset:18432
    ds_read_b64_tr_b16 v[28:29], v75 offset:24576
    ds_read_b64_tr_b16 v[30:31], v75 offset:26624
    s_waitcnt lgkmcnt(6)
    buffer_store_dwordx4 v[16:19], v3, s[24:27], s84 offen offset:0 sc1
    s_waitcnt lgkmcnt(4)
    buffer_store_dwordx4 v[20:23], v3, s[24:27], s84 offen offset:1024 sc1
    s_waitcnt lgkmcnt(2)
    buffer_store_dwordx4 v[24:27], v3, s[24:27], s84 offen offset:2048 sc1
    s_waitcnt lgkmcnt(0)
    buffer_store_dwordx4 v[28:31], v3, s[24:27], s84 offen offset:3072 sc1
K_PACKD:
    s_mov_b32 s80, 4
    s_mov_b32 s81, 12
    s_branch K_ARRIVE
K_IDLE:
    v_lshlrev_b32 v3, 4, v0
    v_mov_b32 v16, 0
    v_mov_b32 v17, 0
    v_mov_b32 v18, 0
    v_mov_b32 v19, 0
    s_mov_b32 s80, 8462336
    buffer_store_dwordx4 v[16:19], v3, s[24:27], s80 offen sc1
    s_branch K_PACKD
K_SETL:
    s_mov_b64 s[24:25], s[66:67]
    s_mov_b32 s26, 8464640
    s_mov_b32 s27, 0x00020000
    s_mov_b64 s[48:49], s[6:7]
    s_mov_b32 s50, 60000
    s_mov_b32 s51, 0x00020000
    s_mov_b64 s[36:37], s[14:15]
    s_mov_b32 s38, 264704
    s_mov_b32 s39, 0x00020000
    s_mov_b64 s[40:41], s[16:17]
    s_mov_b32 s42, 512
    s_mov_b32 s43, 0x00020000
    s_mov_b32 s96, 0xbfb8aa3b
    s_mov_b32 s97, 0xbfb8aa3b
    s_lshl_b32 s88, s3, 6
    s_lshl_b32 s92, s3, 14
    s_add_u32 s64, s92, 5242880
    s_add_u32 s98, s64, 262144
    v_and_b32 v8, 31, v1
    v_lshrrev_b32_e64 v9, 5, v1
    v_mul_u32_u24 v10, 21846, v0
    v_lshrrev_b32 v10, 16, v10
    v_mul_u32_u24 v11, 3, v10
    v_sub_u32 v11, v0, v11
    v_lshlrev_b32 v249, 8, v10
    v_add_u32 v249, s2, v249
    v_mul_u32_u24 v249, 6, v249
    v_lshl_add_u32 v249, v11, 1, v249
    buffer_load_short_d16_hi v208, v249, s[48:51], 0 offen
    v_lshlrev_b32_e64 v10, 4, v10
    v_lshl_add_u32 v209, v11, 2, v10
    v_add_u32 v209, 22400, v209
    v_lshlrev_b32 v10, 1, v8
    v_add_u32 v10, s88, v10
    v_lshlrev_b32 v11, 9, v9
    v_sub_u32 v11, v10, v11
    v_add_u32 v11, 262656, v11
    v_lshl_add_u32 v10, v9, 16, v10
    v_add_u32 v10, 262656, v10
    buffer_load_short_d16_hi v204, v11, s[36:39], 0 offen
    buffer_load_short_d16_hi v205, v10, s[36:39], 0 offen offset:512
    buffer_load_short_d16_hi v206, v10, s[36:39], 0 offen offset:1024
    buffer_load_short_d16_hi v207, v10, s[36:39], 0 offen offset:1536
    v_and_b32_e64 v10, 15, v1
    v_bfe_u32 v11, v1, 4, 1
    v_xor_b32 v10, v10, v11
    v_lshlrev_b32 v10, 10, v10
    v_lshl_add_u32 v11, v9, 3, v10
    buffer_load_dwordx2 v[212:213], v11, s[40:43], s88 offen offset:0
    buffer_load_dwordx2 v[214:215], v11, s[40:43], s88 offen offset:16
    buffer_load_dwordx2 v[216:217], v11, s[40:43], s88 offen offset:32
    buffer_load_dwordx2 v[218:219], v11, s[40:43], s88 offen offset:48
    s_setpc_b64 s[90:91]
K_SETA:
    v_and_b32 v8, 31, v1
    v_lshrrev_b32 v9, 5, v1
    v_lshlrev_b32 v248, 4, v1
    s_lshl_b32 s88, s3, 6
    s_mov_b64 s[28:29], s[66:67]
    s_or_b32 s29, s29, 0x2000000
    s_mov_b32 s30, 10000
    s_mov_b32 s31, 0x00020000
    s_mov_b64 s[44:45], s[20:21]
    s_mov_b32 s46, 5120000
    s_mov_b32 s47, 0x00020000
    s_add_u32 s52, s20, 5120000
    s_addc_u32 s53, s21, 0
    s_mov_b32 s54, 60000
    s_mov_b32 s55, 0x00020000
    s_mov_b32 s85, 0
    s_mov_b32 s99, 0
    s_mov_b32 s86, 0
    s_mul_i32 s87, s3, 6144
    s_add_u32 s87, s87, 112640
    v_mov_b32 v231, 0x3f80
    v_lshrrev_b32 v252, 3, v0
    v_mul_u32_u24_e64 v253, 20, v252
    v_add_u32 v253, 21120, v253
    v_and_b32_e64 v2, 3, v1
    v_bfe_u32 v3, v1, 3, 2
    v_lshl_add_u32 v3, v3, 2, v2
    v_mul_u32_u24 v254, 1040, v3
    v_bfe_u32 v3, v1, 2, 1
    v_lshl_add_u32 v254, v3, 9, v254
    v_lshl_add_u32 v254, v9, 4, v254
    v_mul_u32_u24 v255, 1040, v2
    v_bfe_u32 v4, v1, 3, 1
    v_lshl_add_u32 v255, v4, 9, v255
    v_lshl_add_u32 v255, v9, 4, v255
    v_add_u32 v255, 16640, v255
    v_lshl_add_u32 v2, v4, 2, v2
    v_mul_u32_u24 v7, 528, v2
    v_lshl_add_u32 v7, v9, 4, v7
    v_add_u32 v7, 16896, v7
    v_bfe_u32 v4, v1, 4, 1
    v_cmp_eq_u32 s[94:95], v3, v4
    v_mov_b32 v2, 0x40000
    v_mul_u32_u24 v6, 528, v8
    v_cndmask_b32 v255, v2, v255, s[94:95]
    v_cndmask_b32 v7, v2, v7, s[94:95]
    v_lshl_add_u32 v6, v9, 4, v6
    v_and_b32_e64 v2, 7, v1
    v_mul_u32_u24 v229, 528, v2
    v_lshl_add_u32 v229, v9, 3, v229
    v_add_u32_e64 v229, s88, v229
    v_bfe_u32 v2, v1, 3, 2
    v_lshl_add_u32 v229, v2, 18, v229
    s_mul_i32 s92, s3, 640
    s_add_u32 s92, s92, 103424
    v_lshlrev_b32 v230, 3, v1
    v_add_u32 v230, s92, v230
    v_lshrrev_b32_e64 v2, 4, v1
    v_lshl_add_u32 v230, v2, 18, v230
    v_lshlrev_b32 v2, 3, v9
    v_sub_u32 v2, v8, v2
    v_and_b32 v3, 1, v2
    v_lshlrev_b32 v3, 4, v3
    v_lshlrev_b32 v3, v3, v231
    v_lshrrev_b32 v2, 1, v2
    v_cmp_eq_u32 s[92:93], 0, v2
    v_cmp_eq_u32 s[94:95], 1, v2
    s_nop 0
    v_cndmask_b32 v192, 0, v3, s[92:93]
    v_cndmask_b32 v193, 0, v3, s[94:95]
    v_cmp_eq_u32 s[92:93], 2, v2
    v_cmp_eq_u32 s[94:95], 3, v2
    s_nop 0
    v_cndmask_b32 v194, 0, v3, s[92:93]
    v_cndmask_b32 v195, 0, v3, s[94:95]
    v_cmp_eq_u32 s[92:93], 8, v2
    v_cmp_eq_u32 s[94:95], 9, v2
    s_nop 0
    v_cndmask_b32 v196, 0, v3, s[92:93]
    v_cndmask_b32 v197, 0, v3, s[94:95]
    v_cmp_eq_u32 s[92:93], 10, v2
    v_cmp_eq_u32 s[94:95], 11, v2
    s_nop 0
    v_cndmask_b32 v198, 0, v3, s[92:93]
    v_cndmask_b32 v199, 0, v3, s[94:95]
    v_and_b32_e64 v2, 0x33, v1
    v_bfe_u32 v3, v1, 2, 1
    v_lshl_or_b32 v2, v3, 3, v2
    v_bfe_u32 v3, v1, 3, 1
    v_lshl_or_b32 v2, v3, 2, v2
    v_lshlrev_b32_e64 v224, 4, v2
    v_add_u32 v224, 23040, v224
    v_add_u32 v225, 23040, v248
    v_and_b32_e64 v3, 0x3c, v1
    v_add_u32 v226, 108544, v3
    v_and_b32_e64 v3, 31, v2
    v_bfe_u32 v4, v2, 2, 2
    v_xor_b32 v4, v4, v9
    v_lshlrev_b32 v4, 4, v4
    v_lshl_add_u32 v4, v3, 6, v4
    v_add_u32 v227, s87, v4
    v_xor_b32 v4, 32, v4
    v_add_u32 v228, s87, v4
    v_and_b32 v3, 3, v1
    v_lshrrev_b32 v4, 4, v1
    v_xor_b32 v3, v3, v4
    v_lshlrev_b32 v221, 4, v3
    v_mov_b32_e64 v223, v221
    s_setpc_b64 s[90:91]
K_P2:
    s_waitcnt lgkmcnt(0)
    s_barrier
    buffer_load_dwordx2 v[156:157], v15, s[8:11], 0 offen offset:0 sc1
    v_mov_b32 v232, 0
    v_mov_b32 v233, 0
    v_mov_b32 v234, 0
    v_mov_b32 v235, 0
    v_lshlrev_b32_e64 v10, 4, v0
    v_add_u32 v10, 23040, v10
    v_add_u32 v11, 0x10000, v10
    ds_write_b128 v10, v[232:235] offset:0
    ds_write_b128 v10, v[232:235] offset:8192
    ds_write_b128 v10, v[232:235] offset:16384
    ds_write_b128 v10, v[232:235] offset:24576
    ds_write_b128 v10, v[232:235] offset:32768
    ds_write_b128 v10, v[232:235] offset:40960
    ds_write_b128 v10, v[232:235] offset:49152
    ds_write_b128 v10, v[232:235] offset:57344
    ds_write_b128 v11, v[232:235]
    ds_write_b128 v11, v[232:235] offset:8192
    v_mov_b32 v236, 0x7fff
    v_mov_b32 v237, 0x7fff
    v_lshlrev_b32_e64 v10, 3, v0
    v_add_u32 v10, 108544, v10
    ds_write_b64 v10, v[236:237]
    s_cmp_eq_u32 s62, 0
    s_cbranch_scc1 K_SETD
    s_call_b64 s[90:91], K_SETA
K_SETD:
    s_waitcnt vmcnt(0)
    v_pk_mul_f32 v[204:205], v[204:205], s[96:97]
    v_pk_mul_f32 v[206:207], v[206:207], s[96:97]
    v_cvt_pk_bf16_f32 v202, v204, v205
    v_cvt_pk_bf16_f32 v203, v206, v207
    v_cmp_gt_u32 vcc, 120, v0
    s_and_saveexec_b64 s[94:95], vcc
    ds_write_b32 v209, v208
    s_mov_b64 exec, -1
    s_waitcnt lgkmcnt(0)
    s_barrier
    s_mov_b32 s63, 0
K_POLLP:
    v_cmp_ne_u32 vcc, 0, v157
    s_cmp_lg_u64 vcc, 0
    s_cbranch_scc1 K_GOTP
    s_add_u32 s63, s63, 1
    s_cmp_gt_u32 s63, 0x40000
    s_cbranch_scc1 K_GOTP
    s_sleep 1
    buffer_load_dwordx2 v[156:157], v15, s[8:11], 0 offen offset:0 sc1
    s_waitcnt vmcnt(0)
    s_branch K_POLLP
K_GOTP:
    s_and_b32 s92, s2, 7
    s_cmp_gt_u32 s62, s3
    s_cbranch_scc0 K_NOSIG
    s_lshl_b32 s93, s92, 8
    s_add_u32 s93, s93, 8462336
    s_add_u32 s94, s66, s93
    s_addc_u32 s95, s67, 0
    s_mov_b32 s89, 1
    s_atomic_add s89, s[94:95], 0 glc
K_NOSIG:
    s_lshl_b32 s92, s92, 5
    s_lshr_b32 s93, s2, 3
    s_add_u32 s92, s92, s93
    s_lshl_b32 s92, s92, 10
    s_add_u32 s92, s92, 5636096
    v_lshlrev_b32 v9, 4, v252
    s_add_u32 s101, s64, 0
    buffer_load_dwordx4 v[80:83], v248, s[24:27], s101 offen offset:0
    buffer_load_dwordx4 v[84:87], v248, s[24:27], s101 offen offset:1024
    buffer_load_dwordx4 v[88:91], v248, s[24:27], s101 offen offset:2048
    buffer_load_dwordx4 v[92:95], v248, s[24:27], s101 offen offset:3072
    s_add_u32 s101, s64, 4096
    buffer_load_dwordx4 v[96:99], v248, s[24:27], s101 offen offset:0
    s_cmp_gt_u32 s62, s3
    s_cbranch_scc0 K_NOSIG2
    s_and_b32 s94, s2, 7
    s_cmp_lt_u32 s94, 3
    s_cselect_b32 s93, 22, 21
    s_waitcnt lgkmcnt(0)
    s_cmp_lg_u32 s89, s93
    s_cbranch_scc1 K_NOSIG2
    s_lshl_b32 s94, s94, 2
    s_add_u32 s94, s94, 8464384
    s_add_u32 s94, s66, s94
    s_addc_u32 s95, s67, 0
    s_mov_b32 s82, 1
    s_atomic_add s82, s[94:95], 0
K_NOSIG2:
    buffer_load_dwordx4 v[100:103], v248, s[24:27], s101 offen offset:1024
    buffer_load_dwordx4 v[104:107], v248, s[24:27], s101 offen offset:2048
    buffer_load_dwordx2 v[156:157], v15, s[8:11], 0 offen offset:0 sc1
    buffer_load_dwordx4 v[108:111], v248, s[24:27], s101 offen offset:3072
    s_add_u32 s101, s64, 8192
    buffer_load_dwordx4 v[112:115], v248, s[24:27], s101 offen offset:0
    buffer_load_dwordx4 v[116:119], v248, s[24:27], s101 offen offset:1024
    s_waitcnt vmcnt(3)
    s_mov_b32 s63, 0
K_POLLS:
    v_cmp_ne_u32 vcc, 0, v156
    s_cmp_lg_u64 vcc, 0
    s_cbranch_scc1 K_GOTS
    s_add_u32 s63, s63, 1
    s_cmp_gt_u32 s63, 0x40000
    s_cbranch_scc1 K_GOTS
    s_sleep 1
    buffer_load_dwordx2 v[156:157], v15, s[8:11], 0 offen offset:0 sc1
    s_waitcnt vmcnt(0)
    s_branch K_POLLS
K_GOTS:
    buffer_load_dwordx3 v[12:14], v9, s[24:27], s92 offen
    buffer_load_dwordx3 v[2:4], v248, s[24:27], s92 offen
    buffer_load_dwordx4 v[120:123], v248, s[24:27], s101 offen offset:2048
    buffer_load_dwordx4 v[124:127], v248, s[24:27], s101 offen offset:3072
    s_add_u32 s101, s64, 12288
    buffer_load_dwordx4 v[128:131], v248, s[24:27], s101 offen offset:0
    v_mul_u32_u24 v252, 2504, v252
    v_and_b32_e64 v5, 7, v0
    s_mov_b32 s94, 5898240
    s_waitcnt vmcnt(4)
    v_add_u32_sdwa v250, v12, v5 dst_sel:DWORD dst_unused:UNUSED_PAD src0_sel:WORD_0 src1_sel:DWORD
    v_sub_u32_sdwa v251, v14, v250 dst_sel:DWORD dst_unused:UNUSED_PAD src0_sel:WORD_1 src1_sel:DWORD
    v_add_u32 v10, v252, v250
    v_lshlrev_b32_e64 v10, 4, v10
    v_cmp_lt_i32 s[56:57], 0, v251
    v_cmp_lt_i32 s[58:59], 8, v251
    v_cmp_lt_i32 s[60:61], 16, v251
    v_mov_b32 v11, 8464640
    v_lshrrev_b32_e64 v13, 3, v1
    v_cndmask_b32 v12, v11, v10, s[56:57]
    buffer_load_dwordx4 v[144:147], v12, s[24:27], s94 offen offset:0
    v_cndmask_b32 v12, v11, v10, s[58:59]
    buffer_load_dwordx4 v[148:151], v12, s[24:27], s94 offen offset:128
    v_cndmask_b32 v12, v11, v10, s[60:61]
    buffer_load_dwordx4 v[152:155], v12, s[24:27], s94 offen offset:256
    v_cmp_eq_u32 vcc, s3, v13
    v_mul_u32_u24 v13, 20, v1
    v_add_u32 v13, 21120, v13
    v_cndmask_b32_e64 v5, v11, v13, vcc
    s_waitcnt vmcnt(6)
    v_sub_u32_sdwa v8, v2, v2 dst_sel:DWORD dst_unused:UNUSED_PAD src0_sel:WORD_1 src1_sel:WORD_0
    v_sub_u32_sdwa v9, v3, v2 dst_sel:DWORD dst_unused:UNUSED_PAD src0_sel:WORD_0 src1_sel:WORD_1
    v_sub_u32_sdwa v10, v3, v3 dst_sel:DWORD dst_unused:UNUSED_PAD src0_sel:WORD_1 src1_sel:WORD_0
    v_sub_u32_sdwa v11, v4, v3 dst_sel:DWORD dst_unused:UNUSED_PAD src0_sel:WORD_0 src1_sel:WORD_1
    v_sub_u32_sdwa v12, v4, v4 dst_sel:DWORD dst_unused:UNUSED_PAD src0_sel:WORD_1 src1_sel:WORD_0
    v_add_u32_dpp v8, v8, v8 row_shr:1 row_mask:0xf bank_mask:0xf bound_ctrl:1
    v_add_u32_dpp v9, v9, v9 row_shr:1 row_mask:0xf bank_mask:0xf bound_ctrl:1
    v_add_u32_dpp v10, v10, v10 row_shr:1 row_mask:0xf bank_mask:0xf bound_ctrl:1
    v_add_u32_dpp v11, v11, v11 row_shr:1 row_mask:0xf bank_mask:0xf bound_ctrl:1
    v_add_u32_dpp v12, v12, v12 row_shr:1 row_mask:0xf bank_mask:0xf bound_ctrl:1
    v_add_u32_dpp v8, v8, v8 row_shr:2 row_mask:0xf bank_mask:0xf bound_ctrl:1
    v_add_u32_dpp v9, v9, v9 row_shr:2 row_mask:0xf bank_mask:0xf bound_ctrl:1
    v_add_u32_dpp v10, v10, v10 row_shr:2 row_mask:0xf bank_mask:0xf bound_ctrl:1
    v_add_u32_dpp v11, v11, v11 row_shr:2 row_mask:0xf bank_mask:0xf bound_ctrl:1
    v_add_u32_dpp v12, v12, v12 row_shr:2 row_mask:0xf bank_mask:0xf bound_ctrl:1
    buffer_load_dwordx4 v[132:135], v248, s[24:27], s101 offen offset:1024
    v_add_u32_dpp v8, v8, v8 row_shr:4 row_mask:0xf bank_mask:0xf bound_ctrl:1
    v_add_u32_dpp v9, v9, v9 row_shr:4 row_mask:0xf bank_mask:0xf bound_ctrl:1
    v_add_u32_dpp v10, v10, v10 row_shr:4 row_mask:0xf bank_mask:0xf bound_ctrl:1
    v_add_u32_dpp v11, v11, v11 row_shr:4 row_mask:0xf bank_mask:0xf bound_ctrl:1
    v_add_u32_dpp v12, v12, v12 row_shr:4 row_mask:0xf bank_mask:0xf bound_ctrl:1
    v_add_u32_dpp v8, v8, v8 row_shr:8 row_mask:0xf bank_mask:0xf bound_ctrl:1
    v_add_u32_dpp v9, v9, v9 row_shr:8 row_mask:0xf bank_mask:0xf bound_ctrl:1
    v_add_u32_dpp v10, v10, v10 row_shr:8 row_mask:0xf bank_mask:0xf bound_ctrl:1
    v_add_u32_dpp v11, v11, v11 row_shr:8 row_mask:0xf bank_mask:0xf bound_ctrl:1
    v_add_u32_dpp v12, v12, v12 row_shr:8 row_mask:0xf bank_mask:0xf bound_ctrl:1
    v_add_u32_dpp v8, v8, v8 row_bcast:15 row_mask:0xa bank_mask:0xf
    v_add_u32_dpp v9, v9, v9 row_bcast:15 row_mask:0xa bank_mask:0xf
    v_add_u32_dpp v10, v10, v10 row_bcast:15 row_mask:0xa bank_mask:0xf
    v_add_u32_dpp v11, v11, v11 row_bcast:15 row_mask:0xa bank_mask:0xf
    v_add_u32_dpp v12, v12, v12 row_bcast:15 row_mask:0xa bank_mask:0xf
    buffer_load_dwordx4 v[136:139], v248, s[24:27], s101 offen offset:2048
    v_add_u32_dpp v8, v8, v8 row_bcast:31 row_mask:0xc bank_mask:0xf
    v_add_u32_dpp v9, v9, v9 row_bcast:31 row_mask:0xc bank_mask:0xf
    v_add_u32_dpp v10, v10, v10 row_bcast:31 row_mask:0xc bank_mask:0xf
    v_add_u32_dpp v11, v11, v11 row_bcast:31 row_mask:0xc bank_mask:0xf
    v_add_u32_dpp v12, v12, v12 row_bcast:31 row_mask:0xc bank_mask:0xf
    s_nop 0
    v_readlane_b32 s68, v8, 63
    v_readlane_b32 s69, v9, 63
    v_readlane_b32 s70, v10, 63
    v_readlane_b32 s71, v11, 63
    v_readlane_b32 s72, v12, 63
    v_sub_u32_sdwa v8, v8, v2 dst_sel:DWORD dst_unused:UNUSED_PAD src0_sel:DWORD src1_sel:WORD_1
    v_sub_u32_sdwa v9, v9, v3 dst_sel:DWORD dst_unused:UNUSED_PAD src0_sel:DWORD src1_sel:WORD_0
    v_sub_u32_sdwa v10, v10, v3 dst_sel:DWORD dst_unused:UNUSED_PAD src0_sel:DWORD src1_sel:WORD_1
    buffer_load_dwordx4 v[140:143], v248, s[24:27], s101 offen offset:3072
    v_sub_u32_sdwa v11, v11, v4 dst_sel:DWORD dst_unused:UNUSED_PAD src0_sel:DWORD src1_sel:WORD_0
    v_sub_u32_sdwa v12, v12, v4 dst_sel:DWORD dst_unused:UNUSED_PAD src0_sel:DWORD src1_sel:WORD_1
    s_mov_b32 s73, 0
    s_mov_b32 s89, 0
    s_mov_b32 s81, 0
    s_add_u32 s92, s68, 31
    v_lshl_add_u32 v8, s73, 5, v8
    s_lshr_b32 s93, s92, 5
    s_max_u32 s93, s93, 1
    s_add_u32 s74, s73, s93
    s_bitset1_b32 s89, s74
    s_bitcmp0_b32 s92, 4
    s_cselect_b32 s93, s74, 0
    s_bitset1_b32 s81, s93
    s_add_u32 s92, s69, 31
    v_lshl_add_u32 v9, s74, 5, v9
    s_lshr_b32 s93, s92, 5
    s_max_u32 s93, s93, 1
    s_add_u32 s75, s74, s93
    s_bitset1_b32 s89, s75
    s_bitcmp0_b32 s92, 4
    s_cselect_b32 s93, s75, 0
    s_bitset1_b32 s81, s93
    s_add_u32 s92, s70, 31
    v_lshl_add_u32 v10, s75, 5, v10
    s_lshr_b32 s93, s92, 5
    s_max_u32 s93, s93, 1
    s_add_u32 s76, s75, s93
    s_bitset1_b32 s89, s76
    s_bitcmp0_b32 s92, 4
    s_cselect_b32 s93, s76, 0
    s_bitset1_b32 s81, s93
    s_add_u32 s92, s71, 31
    v_lshl_add_u32 v11, s76, 5, v11
    s_lshr_b32 s93, s92, 5
    s_max_u32 s93, s93, 1
    s_add_u32 s77, s76, s93
    s_bitset1_b32 s89, s77
    s_bitcmp0_b32 s92, 4
    s_cselect_b32 s93, s77, 0
    s_bitset1_b32 s81, s93
    s_add_u32 s92, s72, 31
    v_lshl_add_u32 v12, s77, 5, v12
    s_lshr_b32 s93, s92, 5
    s_max_u32 s93, s93, 1
    s_add_u32 s78, s77, s93
    s_bitset1_b32 s89, s78
    s_bitcmp0_b32 s92, 4
    s_cselect_b32 s93, s78, 0
    s_bitset1_b32 s81, s93
    s_lshr_b32 s81, s81, 1
    s_mov_b32 s84, s78
    s_andn2_b32 s79, s89, 1
    s_lshl_b32 s92, 1, s84
    s_andn2_b32 s80, s89, s92
    s_lshr_b32 s92, s92, 1
    s_or_b32 s82, s79, s92
    s_lshr_b32 s92, s80, 2
    s_or_b32 s82, s82, s92
    s_lshr_b32 s92, s81, 1
    s_or_b32 s82, s82, s92
    s_mov_b32 s83, 0
    ds_write2_b32 v5, v8, v9 offset0:0 offset1:1
    ds_write2_b32 v5, v10, v11 offset0:2 offset1:3
    ds_write_b32 v5, v12 offset:16
    v_and_b32 v15, 7, v1
    v_lshlrev_b32_e64 v15, 2, v15
    v_add_u32 v15, 8464384, v15
    buffer_load_dword v156, v15, s[24:27], 0 offen sc1
    s_waitcnt vmcnt(4)
    buffer_load_dwordx2 v[158:159], v147, s[48:51], 0 offen
    v_bfe_u32 v2, v146, 19, 3
    v_lshl_add_u32 v2, v2, 2, v253
    ds_read_b32 v2, v2
    buffer_load_dwordx2 v[160:161], v151, s[48:51], 0 offen
    v_bfe_u32 v3, v150, 19, 3
    v_lshl_add_u32 v3, v3, 2, v253
    ds_read_b32 v3, v3
    buffer_load_dwordx2 v[162:163], v155, s[48:51], 0 offen
    v_bfe_u32 v4, v154, 19, 3
    v_lshl_add_u32 v4, v4, 2, v253
    ds_read_b32 v4, v4
    s_waitcnt lgkmcnt(0)
    v_add3_u32 v2, v250, v2, 0
    v_cmp_gt_u32 vcc, 832, v2
    v_mov_b32 v10, 0x10000
    s_and_b64 vcc, vcc, s[56:57]
    v_and_b32 v13, 0x3fff, v146
    v_cndmask_b32_e64 v2, v10, v2, vcc
    v_lshrrev_b32 v10, 5, v2
    v_mul_u32_u24 v10, 3072, v10
    v_lshlrev_b32_e64 v11, 2, v2
    v_add_u32 v11, 108544, v11
    ds_write_b32 v11, v13
    v_and_b32_e64 v11, 31, v2
    v_lshl_add_u32 v147, v11, 4, v10
    ds_write_b64 v147, v[144:145] offset:23048
    v_lshrrev_b32_e64 v12, 23, v146
    v_lshl_add_u32 v12, v12, 1, v147
    ds_write_b16 v12, v231 offset:23040
    v_and_b32_e64 v13, 7, v2
    v_lshl_add_u32 v10, v13, 1, v10
    v_and_b32_e64 v13, 24, v2
    v_lshl_add_u32 v10, v13, 6, v10
    v_bfe_u32 v13, v146, 16, 3
    v_lshl_add_u32 v144, v13, 4, v10
    ds_write_b16 v144, v231 offset:24064
    v_add3_u32 v3, v250, v3, 8
    v_cmp_gt_u32 vcc, 832, v3
    v_mov_b32 v10, 0x10000
    s_and_b64 vcc, vcc, s[58:59]
    v_and_b32 v13, 0x3fff, v150
    v_cndmask_b32_e64 v3, v10, v3, vcc
    v_lshrrev_b32 v10, 5, v3
    v_mul_u32_u24 v10, 3072, v10
    v_lshlrev_b32_e64 v11, 2, v3
    v_add_u32 v11, 108544, v11
    ds_write_b32 v11, v13
    v_and_b32_e64 v11, 31, v3
    v_lshl_add_u32 v151, v11, 4, v10
    ds_write_b64 v151, v[148:149] offset:23048
    v_lshrrev_b32_e64 v12, 23, v150
    v_lshl_add_u32 v12, v12, 1, v151
    ds_write_b16 v12, v231 offset:23040
    v_and_b32_e64 v13, 7, v3
    v_lshl_add_u32 v10, v13, 1, v10
    v_and_b32_e64 v13, 24, v3
    v_lshl_add_u32 v10, v13, 6, v10
    v_bfe_u32 v13, v150, 16, 3
    v_lshl_add_u32 v148, v13, 4, v10
    ds_write_b16 v148, v231 offset:24064
    s_cmp_eq_u64 s[60:61], 0
    s_cbranch_scc1 K_SCAT_DONE
    v_add3_u32 v4, v250, v4, 16
    v_cmp_gt_u32 vcc, 832, v4
    v_mov_b32 v10, 0x10000
    s_and_b64 vcc, vcc, s[60:61]
    v_and_b32 v13, 0x3fff, v154
    v_cndmask_b32_e64 v4, v10, v4, vcc
    v_lshrrev_b32 v10, 5, v4
    v_mul_u32_u24 v10, 3072, v10
    v_lshlrev_b32_e64 v11, 2, v4
    v_add_u32 v11, 108544, v11
    ds_write_b32 v11, v13
    v_and_b32_e64 v11, 31, v4
    v_lshl_add_u32 v155, v11, 4, v10
    ds_write_b64 v155, v[152:153] offset:23048
    v_lshrrev_b32_e64 v12, 23, v154
    v_lshl_add_u32 v12, v12, 1, v155
    ds_write_b16 v12, v231 offset:23040
    v_and_b32_e64 v13, 7, v4
    v_lshl_add_u32 v10, v13, 1, v10
    v_and_b32_e64 v13, 24, v4
    v_lshl_add_u32 v10, v13, 6, v10
    v_bfe_u32 v13, v154, 16, 3
    v_lshl_add_u32 v152, v13, 4, v10
    ds_write_b16 v152, v231 offset:24064
    s_mov_b32 s92, 24
K_GEN:
    s_mov_b64 exec, -1
    v_cmp_lt_i32 vcc, s92, v251
    s_and_b64 exec, exec, vcc
    s_cbranch_execz K_SCAT_DONE
    v_add_u32 v8, s92, v250
    v_add_u32 v3, v252, v8
    v_lshlrev_b32 v3, 4, v3
    s_mov_b32 s94, 5898240
    buffer_load_dwordx4 v[232:235], v3, s[24:27], s94 offen
    s_waitcnt vmcnt(0)
    buffer_load_dwordx2 v[236:237], v235, s[48:51], 0 offen
    v_bfe_u32 v9, v234, 19, 3
    v_lshl_add_u32 v9, v9, 2, v253
    ds_read_b32 v9, v9
    v_bfe_u32 v13, v234, 16, 6
    v_lshlrev_b32 v13, 4, v13
    ds_read_b96 v[184:186], v13 offset:22400
    v_subrev_u32 v8, s99, v8
    s_waitcnt vmcnt(0) lgkmcnt(0)
    v_add_u32_e64 v8, v8, v9
    v_cmp_gt_u32 vcc, 832, v8
    v_mov_b32 v10, 0x10000
    s_and_b64 vcc, vcc, exec
    v_and_b32 v13, 0x3fff, v234
    v_cndmask_b32_e64 v8, v10, v8, vcc
    v_lshrrev_b32 v10, 5, v8
    v_mul_u32_u24 v10, 3072, v10
    v_lshlrev_b32_e64 v11, 2, v8
    v_add_u32 v11, 108544, v11
    ds_write_b32 v11, v13
    v_and_b32_e64 v11, 31, v8
    v_lshl_add_u32 v235, v11, 4, v10
    ds_write_b64 v235, v[232:233] offset:23048
    v_lshrrev_b32_e64 v12, 23, v234
    v_lshl_add_u32 v12, v12, 1, v235
    ds_write_b16 v12, v231 offset:23040
    v_and_b32_e64 v13, 7, v8
    v_lshl_add_u32 v10, v13, 1, v10
    v_and_b32_e64 v13, 24, v8
    v_lshl_add_u32 v10, v13, 6, v10
    v_bfe_u32 v13, v234, 16, 3
    v_lshl_add_u32 v232, v13, 4, v10
    ds_write_b16 v232, v231 offset:24064
    v_lshlrev_b32_e64 v12, 4, v234
    v_alignbit_b32 v236, v237, v236, v12
    v_lshrrev_b32 v237, v12, v237
    v_lshlrev_b32 v13, 16, v236
    v_and_b32 v14, 0xffff0000, v236
    v_lshlrev_b32 v12, 16, v237
    v_sub_f32 v184, v184, v13
    v_sub_f32 v185, v185, v14
    v_sub_f32 v186, v186, v12
    v_cvt_pk_bf16_f32 v12, 0, v184
    v_cvt_pk_bf16_f32 v237, v185, v186
    v_dot2_f32_bf16 v13, v12, v12, 0
    v_dot2_f32_bf16 v13, v237, v237, v13
    ds_write_b16_d16_hi v232, v12 offset:24192
    ds_write_b16 v232, v237 offset:24320
    ds_write_b16_d16_hi v232, v237 offset:24448
    v_cvt_pk_bf16_f32 v236, v13, v184
    ds_write_b64 v235, v[236:237] offset:23560
    s_add_u32 s92, s92, 8
    s_branch K_GEN
K_SCAT_DONE:
    s_mov_b64 exec, -1
    s_cmp_lg_u32 s85, 0
    s_cbranch_scc1 K_GOTB
    s_cmp_le_u32 s78, 26
    s_cbranch_scc1 K_ONER
    s_sub_u32 s84, s78, s85
    s_min_u32 s84, s84, 26
    s_mov_b32 s89, 0
    s_mov_b32 s81, 0
    s_sub_u32 s92, s74, s85
    s_lshl_b32 s93, 1, s92
    s_cmp_le_u32 s92, s84
    s_cselect_b32 s93, s93, 0
    s_or_b32 s89, s89, s93
    s_lshr_b32 s93, s93, 1
    s_sub_u32 s94, s68, 1
    s_max_i32 s94, s94, 0
    s_bitcmp0_b32 s94, 4
    s_cselect_b32 s93, s93, 0
    s_or_b32 s81, s81, s93
    s_sub_u32 s92, s75, s85
    s_lshl_b32 s93, 1, s92
    s_cmp_le_u32 s92, s84
    s_cselect_b32 s93, s93, 0
    s_or_b32 s89, s89, s93
    s_lshr_b32 s93, s93, 1
    s_sub_u32 s94, s69, 1
    s_max_i32 s94, s94, 0
    s_bitcmp0_b32 s94, 4
    s_cselect_b32 s93, s93, 0
    s_or_b32 s81, s81, s93
    s_sub_u32 s92, s76, s85
    s_lshl_b32 s93, 1, s92
    s_cmp_le_u32 s92, s84
    s_cselect_b32 s93, s93, 0
    s_or_b32 s89, s89, s93
    s_lshr_b32 s93, s93, 1
    s_sub_u32 s94, s70, 1
    s_max_i32 s94, s94, 0
    s_bitcmp0_b32 s94, 4
    s_cselect_b32 s93, s93, 0
    s_or_b32 s81, s81, s93
    s_sub_u32 s92, s77, s85
    s_lshl_b32 s93, 1, s92
    s_cmp_le_u32 s92, s84
    s_cselect_b32 s93, s93, 0
    s_or_b32 s89, s89, s93
    s_lshr_b32 s93, s93, 1
    s_sub_u32 s94, s71, 1
    s_max_i32 s94, s94, 0
    s_bitcmp0_b32 s94, 4
    s_cselect_b32 s93, s93, 0
    s_or_b32 s81, s81, s93
    s_sub_u32 s92, s78, s85
    s_lshl_b32 s93, 1, s92
    s_cmp_le_u32 s92, s84
    s_cselect_b32 s93, s93, 0
    s_or_b32 s89, s89, s93
    s_lshr_b32 s93, s93, 1
    s_sub_u32 s94, s72, 1
    s_max_i32 s94, s94, 0
    s_bitcmp0_b32 s94, 4
    s_cselect_b32 s93, s93, 0
    s_or_b32 s81, s81, s93
    s_andn2_b32 s79, s89, 1
    s_lshl_b32 s92, 1, s84
    s_andn2_b32 s80, s89, s92
    s_lshr_b32 s92, s92, 1
    s_or_b32 s82, s79, s92
    s_lshr_b32 s92, s80, 2
    s_or_b32 s82, s82, s92
    s_lshr_b32 s92, s81, 1
    s_or_b32 s82, s82, s92
    s_mov_b32 s83, 0
K_ONER:
    s_waitcnt vmcnt(3)
    s_mov_b32 s63, 0
K_POLLB:
    v_cmp_eq_u32 vcc, 0, v156
    s_cmp_eq_u64 vcc, 0
    s_cbranch_scc1 K_GOTB
    s_add_u32 s63, s63, 1
    s_cmp_gt_u32 s63, 0x40000
    s_cbranch_scc1 K_GOTB
    s_sleep 1
    buffer_load_dword v156, v15, s[24:27], 0 offen sc1
    s_waitcnt vmcnt(0)
    s_branch K_POLLB
K_GOTB:
    s_waitcnt lgkmcnt(0)
    s_barrier
    ds_read_b32 v2, v226 offset:0
    ds_read_b32 v4, v226 offset:64
    ds_read_b32 v8, v226 offset:128
    ds_read_b32 v10, v226 offset:192
    ds_read_b32 v184, v226 offset:256
    ds_read_b32 v186, v226 offset:320
    ds_read_b32 v220, v226 offset:384
    ds_read_b32 v222, v226 offset:448
    v_mov_b32 v3, v221
    v_mov_b32 v5, v221
    v_mov_b32 v9, v221
    v_mov_b32 v11, v221
    v_mov_b32 v185, v221
    v_mov_b32_e64 v187, v221
    s_waitcnt lgkmcnt(0)
    s_add_u32 m0, s87, 0
    s_nop 0
    buffer_load_dwordx4 v[2:3], s[28:31], s88 idxen offen lds
    s_add_u32 m0, s87, 1024
    s_nop 0
    buffer_load_dwordx4 v[4:5], s[28:31], s88 idxen offen lds
    s_cmp_lg_u32 s85, 0
    s_cbranch_scc1 K_LATER
    ds_read_b128 v[16:19], v254 offset:0
    ds_read_b128 v[20:23], v255 offset:0
    ds_read_b128 v[24:27], v254 offset:32
    ds_read_b128 v[28:31], v255 offset:32
    ds_read_b128 v[32:35], v254 offset:64
    ds_read_b128 v[36:39], v255 offset:64
    s_waitcnt lgkmcnt(4)
    v_mfma_f32_32x32x16_bf16 v[164:179], v[16:19], v[80:83], 0
    v_bfe_u32 v13, v146, 16, 6
    v_lshlrev_b32_e64 v13, 4, v13
    ds_read_b96 v[40:42], v13 offset:22400
    v_bfe_u32 v13, v150, 16, 6
    v_lshlrev_b32_e64 v13, 4, v13
    ds_read_b96 v[44:46], v13 offset:22400
    v_bfe_u32 v13, v154, 16, 6
    v_lshlrev_b32_e64 v13, 4, v13
    ds_read_b96 v[48:50], v13 offset:22400
    v_mfma_f32_16x16x32_bf16 v[180:183], v[20:23], v[80:83], 0
    ds_read_b128 v[16:19], v254 offset:96
    ds_read_b128 v[20:23], v255 offset:96
    s_waitcnt lgkmcnt(4)
    v_mfma_f32_32x32x16_bf16 v[164:179], v[24:27], v[84:87], v[164:179]
    v_mfma_f32_16x16x32_bf16 v[180:183], v[28:31], v[84:87], v[180:183]
    ds_read_b128 v[24:27], v254 offset:128
    ds_read_b128 v[28:31], v255 offset:128
    s_waitcnt lgkmcnt(4)
    v_mfma_f32_32x32x16_bf16 v[164:179], v[32:35], v[88:91], v[164:179]
    s_add_u32 m0, s87, 2048
    s_nop 0
    buffer_load_dwordx4 v[8:9], s[28:31], s88 idxen offen lds
    s_waitcnt vmcnt(3)
    v_lshlrev_b32_e64 v12, 4, v146
    v_alignbit_b32 v158, v159, v158, v12
    v_lshrrev_b32_e64 v159, v12, v159
    v_mfma_f32_16x16x32_bf16 v[180:183], v[36:39], v[88:91], v[180:183]
    ds_read_b128 v[32:35], v254 offset:160
    ds_read_b128 v[36:39], v255 offset:160
    s_waitcnt lgkmcnt(4)
    v_mfma_f32_32x32x16_bf16 v[164:179], v[16:19], v[92:95], v[164:179]
    v_lshlrev_b32 v13, 16, v158
    v_and_b32 v14, 0xffff0000, v158
    v_lshlrev_b32_e64 v12, 16, v159
    v_mfma_f32_16x16x32_bf16 v[180:183], v[20:23], v[92:95], v[180:183]
    ds_read_b128 v[16:19], v254 offset:192
    ds_read_b128 v[20:23], v255 offset:192
    s_waitcnt lgkmcnt(4)
    v_mfma_f32_32x32x16_bf16 v[164:179], v[24:27], v[96:99], v[164:179]
    v_sub_f32 v40, v40, v13
    v_sub_f32 v41, v41, v14
    v_sub_f32 v42, v42, v12
    v_mfma_f32_16x16x32_bf16 v[180:183], v[28:31], v[96:99], v[180:183]
    ds_read_b128 v[24:27], v254 offset:224
    ds_read_b128 v[28:31], v255 offset:224
    s_waitcnt lgkmcnt(4)
    v_mfma_f32_32x32x16_bf16 v[164:179], v[32:35], v[100:103], v[164:179]
    s_add_u32 m0, s87, 3072
    s_nop 0
    buffer_load_dwordx4 v[10:11], s[28:31], s88 idxen offen lds
    v_cvt_pk_bf16_f32 v12, 0, v40
    v_cvt_pk_bf16_f32 v159, v41, v42
    v_dot2_f32_bf16 v13, v12, v12, 0
    v_mfma_f32_16x16x32_bf16 v[180:183], v[36:39], v[100:103], v[180:183]
    ds_read_b128 v[32:35], v254 offset:256
    ds_read_b128 v[36:39], v255 offset:256
    s_waitcnt lgkmcnt(4)
    v_mfma_f32_32x32x16_bf16 v[164:179], v[16:19], v[104:107], v[164:179]
    v_dot2_f32_bf16 v13, v159, v159, v13
    ds_write_b16_d16_hi v144, v12 offset:24192
    ds_write_b16 v144, v159 offset:24320
    v_mfma_f32_16x16x32_bf16 v[180:183], v[20:23], v[104:107], v[180:183]
    ds_read_b128 v[16:19], v254 offset:288
    ds_read_b128 v[20:23], v255 offset:288
    s_waitcnt lgkmcnt(4)
    v_mfma_f32_32x32x16_bf16 v[164:179], v[24:27], v[108:111], v[164:179]
    ds_write_b16_d16_hi v144, v159 offset:24448
    v_cvt_pk_bf16_f32 v158, v13, v40
    ds_write_b64 v147, v[158:159] offset:23560
    v_mfma_f32_16x16x32_bf16 v[180:183], v[28:31], v[108:111], v[180:183]
    ds_read_b128 v[24:27], v254 offset:320
    ds_read_b128 v[28:31], v255 offset:320
    s_waitcnt lgkmcnt(4)
    v_mfma_f32_32x32x16_bf16 v[164:179], v[32:35], v[112:115], v[164:179]
    s_add_u32 m0, s87, 4096
    s_nop 0
    buffer_load_dwordx4 v[184:185], s[28:31], s88 idxen offen lds
    v_lshlrev_b32_e64 v12, 4, v150
    v_alignbit_b32 v160, v161, v160, v12
    v_lshrrev_b32_e64 v161, v12, v161
    v_mfma_f32_16x16x32_bf16 v[180:183], v[36:39], v[112:115], v[180:183]
    ds_read_b128 v[32:35], v254 offset:352
    ds_read_b128 v[36:39], v255 offset:352
    s_waitcnt lgkmcnt(4)
    v_mfma_f32_32x32x16_bf16 v[164:179], v[16:19], v[116:119], v[164:179]
    v_lshlrev_b32 v13, 16, v160
    v_and_b32 v14, 0xffff0000, v160
    v_lshlrev_b32_e64 v12, 16, v161
    v_mfma_f32_16x16x32_bf16 v[180:183], v[20:23], v[116:119], v[180:183]
    ds_read_b128 v[16:19], v254 offset:384
    ds_read_b128 v[20:23], v255 offset:384
    s_waitcnt lgkmcnt(4)
    v_mfma_f32_32x32x16_bf16 v[164:179], v[24:27], v[120:123], v[164:179]
    v_sub_f32 v44, v44, v13
    v_sub_f32 v45, v45, v14
    v_sub_f32 v46, v46, v12
    v_mfma_f32_16x16x32_bf16 v[180:183], v[28:31], v[120:123], v[180:183]
    ds_read_b128 v[24:27], v254 offset:416
    ds_read_b128 v[28:31], v255 offset:416
    s_waitcnt lgkmcnt(4)
    v_mfma_f32_32x32x16_bf16 v[164:179], v[32:35], v[124:127], v[164:179]
    s_add_u32 m0, s87, 5120
    s_nop 0
    buffer_load_dwordx4 v[186:187], s[28:31], s88 idxen offen lds
    v_cvt_pk_bf16_f32 v12, 0, v44
    v_cvt_pk_bf16_f32 v161, v45, v46
    v_dot2_f32_bf16 v13, v12, v12, 0
    v_mfma_f32_16x16x32_bf16 v[180:183], v[36:39], v[124:127], v[180:183]
    ds_read_b128 v[32:35], v254 offset:448
    ds_read_b128 v[36:39], v255 offset:448
    s_waitcnt lgkmcnt(4)
    v_mfma_f32_32x32x16_bf16 v[164:179], v[16:19], v[128:131], v[164:179]
    v_dot2_f32_bf16 v13, v161, v161, v13
    ds_write_b16_d16_hi v148, v12 offset:24192
    ds_write_b16 v148, v161 offset:24320
    v_mfma_f32_16x16x32_bf16 v[180:183], v[20:23], v[128:131], v[180:183]
    ds_read_b128 v[16:19], v254 offset:480
    ds_read_b128 v[20:23], v255 offset:480
    s_waitcnt lgkmcnt(4)
    v_mfma_f32_32x32x16_bf16 v[164:179], v[24:27], v[132:135], v[164:179]
    ds_write_b16_d16_hi v148, v161 offset:24448
    v_cvt_pk_bf16_f32 v160, v13, v44
    ds_write_b64 v151, v[160:161] offset:23560
    v_mfma_f32_16x16x32_bf16 v[180:183], v[28:31], v[132:135], v[180:183]
    s_waitcnt lgkmcnt(2)
    v_mfma_f32_32x32x16_bf16 v[164:179], v[32:35], v[136:139], v[164:179]
    v_mov_b64 v[64:65], 0
    v_mov_b64 v[66:67], 0
    v_mov_b64 v[68:69], 0
    v_mov_b64_e64 v[70:71], 0
    v_mfma_f32_16x16x32_bf16 v[180:183], v[36:39], v[136:139], v[180:183]
    s_waitcnt lgkmcnt(0)
    v_mfma_f32_32x32x16_bf16 v[164:179], v[16:19], v[140:143], v[164:179]
    v_mov_b64 v[72:73], 0
    v_mov_b64 v[74:75], 0
    v_mov_b64 v[76:77], 0
    v_mov_b64_e64 v[78:79], 0
    v_mfma_f32_16x16x32_bf16 v[180:183], v[20:23], v[140:143], v[180:183]
    s_cmp_eq_u64 s[60:61], 0
    s_cbranch_scc1 K_NO3
    v_lshlrev_b32_e64 v12, 4, v154
    v_alignbit_b32 v162, v163, v162, v12
    v_lshrrev_b32 v163, v12, v163
    v_lshlrev_b32 v13, 16, v162
    v_and_b32 v14, 0xffff0000, v162
    v_lshlrev_b32 v12, 16, v163
    v_sub_f32 v48, v48, v13
    v_sub_f32 v49, v49, v14
    v_sub_f32 v50, v50, v12
    v_cvt_pk_bf16_f32 v12, 0, v48
    v_cvt_pk_bf16_f32 v163, v49, v50
    v_dot2_f32_bf16 v13, v12, v12, 0
    v_dot2_f32_bf16 v13, v163, v163, v13
    ds_write_b16_d16_hi v152, v12 offset:24192
    ds_write_b16 v152, v163 offset:24320
    ds_write_b16_d16_hi v152, v163 offset:24448
    v_cvt_pk_bf16_f32 v162, v13, v48
    ds_write_b64 v155, v[162:163] offset:23560
K_NO3:
    s_nop 7
    v_pk_mul_f32 v[164:165], v[164:165], s[96:97]
    v_pk_mul_f32 v[166:167], v[166:167], s[96:97]
    v_cvt_pk_bf16_f32 v200, v164, v165
    v_cvt_pk_bf16_f32 v201, v166, v167
    v_pk_mul_f32 v[168:169], v[168:169], s[96:97]
    v_pk_mul_f32 v[170:171], v[170:171], s[96:97]
    v_cvt_pk_bf16_f32 v204, v168, v169
    v_cvt_pk_bf16_f32 v205, v170, v171
    v_pk_mul_f32 v[172:173], v[172:173], s[96:97]
    v_pk_mul_f32 v[174:175], v[174:175], s[96:97]
    v_cvt_pk_bf16_f32 v206, v172, v173
    v_cvt_pk_bf16_f32 v207, v174, v175
    v_pk_mul_f32 v[176:177], v[176:177], s[96:97]
    v_pk_mul_f32 v[178:179], v[178:179], s[96:97]
    v_cvt_pk_bf16_f32 v208, v176, v177
    v_cvt_pk_bf16_f32 v209, v178, v179
    v_pk_mul_f32 v[180:181], v[180:181], s[96:97]
    v_pk_mul_f32 v[182:183], v[182:183], s[96:97]
    v_cvt_pk_bf16_f32 v210, v180, v181
    v_cvt_pk_bf16_f32 v211, v182, v183
    s_waitcnt lgkmcnt(0)
    s_getpc_b64 s[60:61]
K_PC2:
    s_add_u32 s60, s60, K_WH0-K_PC2
    s_addc_u32 s61, s61, 0
    s_barrier
    s_branch K_PIPE
K_LATER:
    s_add_u32 m0, s87, 2048
    s_nop 0
    buffer_load_dwordx4 v[8:9], s[28:31], s88 idxen offen lds
    s_add_u32 m0, s87, 3072
    s_nop 0
    buffer_load_dwordx4 v[10:11], s[28:31], s88 idxen offen lds
    s_add_u32 m0, s87, 4096
    s_nop 0
    buffer_load_dwordx4 v[184:185], s[28:31], s88 idxen offen lds
    s_add_u32 m0, s87, 5120
    s_nop 0
    buffer_load_dwordx4 v[186:187], s[28:31], s88 idxen offen lds
    s_bitcmp1_b32 s89, 0
    s_cbranch_scc0 K_PIPE
    v_mov_b64 v[200:201], v[204:205]
    v_mov_b64 v[204:205], v[206:207]
    v_mov_b64 v[206:207], v[208:209]
    v_mov_b64_e64 v[208:209], v[210:211]
K_PIPE:
    s_waitcnt vmcnt(4)
    ds_read_b128 v[172:175], v227 offset:0
    ds_read_b128 v[176:179], v228 offset:0
    ds_read_b128 v[180:183], v224 offset:0
    v_mov_b64 v[164:165], 0
    v_mov_b64 v[184:185], 0
    v_mov_b64 v[166:167], 0
    v_mov_b64 v[186:187], 0
    v_mov_b64 v[168:169], 0
    v_mov_b64 v[188:189], 0
    v_mov_b64 v[170:171], 0
    v_mov_b64_e64 v[190:191], 0
    s_waitcnt lgkmcnt(0)
    s_add_u32 m0, s87, 0
    s_nop 0
    buffer_load_dwordx4 v[220:221], s[28:31], s88 idxen offen lds
    s_add_u32 m0, s87, 1024
    s_nop 0
    buffer_load_dwordx4 v[222:223], s[28:31], s88 idxen offen lds
    v_mfma_f32_32x32x16_bf16 v[16:31], v[180:183], v[200:203], 0
    v_mfma_f32_32x32x16_bf16 v[16:31], v[172:175], v[192:195], v[16:31]
    v_mfma_f32_32x32x16_bf16 v[16:31], v[176:179], v[196:199], v[16:31]
    s_waitcnt vmcnt(4)
    ds_read_b128 v[172:175], v227 offset:2048
    ds_read_b128 v[176:179], v228 offset:2048
    ds_read_b128 v[180:183], v224 offset:3072
    ds_read_b32 v220, v226 offset:512
    ds_read_b32 v222, v226 offset:576
    s_bitcmp1_b32 s80, 1
    s_cbranch_scc0 K_NOSW
    v_mov_b64 v[200:201], v[204:205]
    v_mov_b64 v[204:205], v[206:207]
    v_mov_b64 v[206:207], v[208:209]
    v_mov_b64_e64 v[208:209], v[210:211]
K_NOSW:
    s_lshl_b32 s92, s79, 1
    s_lshr_b32 s93, s80, 1
    s_lshl_b32 s94, -1, s84
    s_andn2_b32 s92, s92, s94
    s_or_b32 s94, s93, s81
    s_andn2_b32 s56, s92, s94
    s_andn2_b32 s93, s93, s92
    s_andn2_b32 s57, s93, s81
    s_and_b32 s58, s93, s81
    s_setprio 1
    s_nop 7
    s_bitcmp1_b32 s81, 0
    s_cbranch_scc1 K_HALF0
K_FULL0:
    s_cmp_ge_u32 s3, 4
    s_cbranch_scc1 K_PR1
    s_setprio 2
K_PR1:
    s_waitcnt lgkmcnt(0)
    v_mfma_f32_32x32x16_bf16 v[32:47], v[180:183], v[200:203], 0
    v_exp_f32_e64 v48, v16
    s_add_u32 m0, s87, 2048
    v_exp_f32_e64 v49, v17
    buffer_load_dwordx4 v[220:221], s[28:31], s88 idxen offen lds
    v_exp_f32 v50, v18
    v_exp_f32 v51, v19
    v_mfma_f32_32x32x16_bf16 v[32:47], v[172:175], v[192:195], v[32:47]
    v_exp_f32_e64 v52, v20
    s_add_u32 m0, s87, 3072
    v_exp_f32_e64 v53, v21
    buffer_load_dwordx4 v[222:223], s[28:31], s88 idxen offen lds
    v_exp_f32 v54, v22
    v_exp_f32 v55, v23
    v_mfma_f32_32x32x16_bf16 v[32:47], v[176:179], v[196:199], v[32:47]
    v_exp_f32 v56, v24
    v_exp_f32 v57, v25
    v_exp_f32 v58, v26
    v_exp_f32 v59, v27
    v_exp_f32 v60, v28
    v_exp_f32 v61, v29
    v_exp_f32 v62, v30
    v_exp_f32 v63, v31
    v_pk_add_f32 v[48:49], v[48:49], 1.0 op_sel_hi:[1,0]
    v_pk_add_f32 v[50:51], v[50:51], 1.0 op_sel_hi:[1,0]
    v_pk_add_f32 v[52:53], v[52:53], 1.0 op_sel_hi:[1,0]
    v_pk_add_f32 v[54:55], v[54:55], 1.0 op_sel_hi:[1,0]
    v_pk_add_f32 v[56:57], v[56:57], 1.0 op_sel_hi:[1,0]
    v_pk_add_f32 v[58:59], v[58:59], 1.0 op_sel_hi:[1,0]
    v_pk_add_f32 v[60:61], v[60:61], 1.0 op_sel_hi:[1,0]
    v_pk_add_f32 v[62:63], v[62:63], 1.0 op_sel_hi:[1,0]
    v_mfma_f32_32x32x16_bf16 v[64:79], v[164:167], v[184:187], v[64:79]
    v_rcp_f32 v48, v48
    v_rcp_f32 v49, v49
    v_rcp_f32 v50, v50
    v_rcp_f32 v51, v51
    v_mfma_f32_32x32x16_bf16 v[64:79], v[168:171], v[188:191], v[64:79]
    v_rcp_f32 v52, v52
    v_rcp_f32 v53, v53
    v_rcp_f32 v54, v54
    v_rcp_f32_e64 v55, v55
    s_waitcnt vmcnt(4)
    ds_read_b128 v[172:175], v227 offset:4096
    v_rcp_f32_e64 v56, v56
    ds_read_b128 v[176:179], v228 offset:4096
    v_rcp_f32_e64 v57, v57
    ds_read_b128 v[180:183], v224 offset:6144
    v_rcp_f32_e64 v58, v58
    ds_read_b32 v220, v226 offset:640
    v_rcp_f32_e64 v59, v59
    ds_read_b32 v222, v226 offset:704
    v_rcp_f32_e64 v60, v60
    ds_read_b128 v[184:187], v225 offset:1024
    v_rcp_f32_e64 v61, v61
    ds_read_b128 v[188:191], v225 offset:2048
    v_rcp_f32 v62, v62
    v_rcp_f32 v63, v63
    v_pk_mul_f32 v[48:49], v[48:49], v[16:17]
    v_pk_mul_f32 v[50:51], v[50:51], v[18:19]
    v_pk_mul_f32 v[52:53], v[52:53], v[20:21]
    v_pk_mul_f32 v[54:55], v[54:55], v[22:23]
    v_pk_mul_f32 v[56:57], v[56:57], v[24:25]
    v_pk_mul_f32 v[58:59], v[58:59], v[26:27]
    v_pk_mul_f32 v[60:61], v[60:61], v[28:29]
    v_pk_mul_f32 v[62:63], v[62:63], v[30:31]
    v_cvt_pk_bf16_f32 v164, v48, v49
    v_cvt_pk_bf16_f32 v165, v50, v51
    v_cvt_pk_bf16_f32 v166, v52, v53
    v_cvt_pk_bf16_f32 v167, v54, v55
    v_cvt_pk_bf16_f32 v168, v56, v57
    v_cvt_pk_bf16_f32 v169, v58, v59
    v_cvt_pk_bf16_f32 v170, v60, v61
    v_cvt_pk_bf16_f32 v171, v62, v63
    s_bitcmp1_b32 s82, s83
    s_cbranch_scc1 K_EV0
    s_add_u32 s83, s83, 1
K_FULL1:
    s_waitcnt lgkmcnt(0)
    v_mfma_f32_32x32x16_bf16 v[48:63], v[180:183], v[200:203], 0
    v_exp_f32_e64 v16, v32
    s_add_u32 m0, s87, 4096
    v_exp_f32_e64 v17, v33
    buffer_load_dwordx4 v[220:221], s[28:31], s88 idxen offen lds
    v_exp_f32 v18, v34
    v_exp_f32 v19, v35
    v_mfma_f32_32x32x16_bf16 v[48:63], v[172:175], v[192:195], v[48:63]
    v_exp_f32_e64 v20, v36
    s_add_u32 m0, s87, 5120
    v_exp_f32_e64 v21, v37
    buffer_load_dwordx4 v[222:223], s[28:31], s88 idxen offen lds
    v_exp_f32 v22, v38
    v_exp_f32 v23, v39
    v_mfma_f32_32x32x16_bf16 v[48:63], v[176:179], v[196:199], v[48:63]
    v_exp_f32 v24, v40
    v_exp_f32 v25, v41
    v_exp_f32 v26, v42
    v_exp_f32 v27, v43
    v_exp_f32 v28, v44
    v_exp_f32 v29, v45
    v_exp_f32 v30, v46
    v_exp_f32 v31, v47
    v_pk_add_f32 v[16:17], v[16:17], 1.0 op_sel_hi:[1,0]
    v_pk_add_f32 v[18:19], v[18:19], 1.0 op_sel_hi:[1,0]
    v_pk_add_f32 v[20:21], v[20:21], 1.0 op_sel_hi:[1,0]
    v_pk_add_f32 v[22:23], v[22:23], 1.0 op_sel_hi:[1,0]
    v_pk_add_f32 v[24:25], v[24:25], 1.0 op_sel_hi:[1,0]
    v_pk_add_f32 v[26:27], v[26:27], 1.0 op_sel_hi:[1,0]
    v_pk_add_f32 v[28:29], v[28:29], 1.0 op_sel_hi:[1,0]
    v_pk_add_f32 v[30:31], v[30:31], 1.0 op_sel_hi:[1,0]
    v_mfma_f32_32x32x16_bf16 v[64:79], v[164:167], v[184:187], v[64:79]
    v_rcp_f32 v16, v16
    v_rcp_f32 v17, v17
    v_rcp_f32 v18, v18
    v_rcp_f32 v19, v19
    v_mfma_f32_32x32x16_bf16 v[64:79], v[168:171], v[188:191], v[64:79]
    v_rcp_f32 v20, v20
    v_rcp_f32 v21, v21
    v_rcp_f32 v22, v22
    v_rcp_f32_e64 v23, v23
    s_waitcnt vmcnt(4)
    ds_read_b128 v[172:175], v227 offset:0
    v_rcp_f32_e64 v24, v24
    ds_read_b128 v[176:179], v228 offset:0
    v_rcp_f32_e64 v25, v25
    ds_read_b128 v[180:183], v224 offset:9216
    v_rcp_f32_e64 v26, v26
    ds_read_b32 v220, v226 offset:768
    v_rcp_f32_e64 v27, v27
    ds_read_b32 v222, v226 offset:832
    v_rcp_f32_e64 v28, v28
    ds_read_b128 v[184:187], v225 offset:4096
    v_rcp_f32_e64 v29, v29
    ds_read_b128 v[188:191], v225 offset:5120
    v_rcp_f32 v30, v30
    v_rcp_f32 v31, v31
    v_pk_mul_f32 v[16:17], v[16:17], v[32:33]
    v_pk_mul_f32 v[18:19], v[18:19], v[34:35]
    v_pk_mul_f32 v[20:21], v[20:21], v[36:37]
    v_pk_mul_f32 v[22:23], v[22:23], v[38:39]
    v_pk_mul_f32 v[24:25], v[24:25], v[40:41]
    v_pk_mul_f32 v[26:27], v[26:27], v[42:43]
    v_pk_mul_f32 v[28:29], v[28:29], v[44:45]
    v_pk_mul_f32 v[30:31], v[30:31], v[46:47]
    v_cvt_pk_bf16_f32 v164, v16, v17
    v_cvt_pk_bf16_f32 v165, v18, v19
    v_cvt_pk_bf16_f32 v166, v20, v21
    v_cvt_pk_bf16_f32 v167, v22, v23
    v_cvt_pk_bf16_f32 v168, v24, v25
    v_cvt_pk_bf16_f32 v169, v26, v27
    v_cvt_pk_bf16_f32 v170, v28, v29
    v_cvt_pk_bf16_f32 v171, v30, v31
    s_bitcmp1_b32 s82, s83
    s_cbranch_scc1 K_EV1
    s_add_u32 s83, s83, 1
K_FULL2:
    s_cmp_ge_u32 s3, 4
    s_cbranch_scc1 K_PR2
    s_setprio 0
K_PR2:
    s_waitcnt lgkmcnt(0)
    v_mfma_f32_32x32x16_bf16 v[16:31], v[180:183], v[200:203], 0
    v_exp_f32 v32, v48
    s_add_u32 m0, s87, 0
    v_exp_f32 v33, v49
    buffer_load_dwordx4 v[220:221], s[28:31], s88 idxen offen lds
    v_exp_f32 v34, v50
    v_exp_f32 v35, v51
    v_mfma_f32_32x32x16_bf16 v[16:31], v[172:175], v[192:195], v[16:31]
    v_exp_f32_e64 v36, v52
    s_add_u32 m0, s87, 1024
    v_exp_f32_e64 v37, v53
    buffer_load_dwordx4 v[222:223], s[28:31], s88 idxen offen lds
    v_exp_f32 v38, v54
    v_exp_f32 v39, v55
    v_mfma_f32_32x32x16_bf16 v[16:31], v[176:179], v[196:199], v[16:31]
    v_exp_f32 v40, v56
    v_exp_f32 v41, v57
    v_exp_f32 v42, v58
    v_exp_f32 v43, v59
    v_exp_f32 v44, v60
    v_exp_f32 v45, v61
    v_exp_f32 v46, v62
    v_exp_f32 v47, v63
    v_pk_add_f32 v[32:33], v[32:33], 1.0 op_sel_hi:[1,0]
    v_pk_add_f32 v[34:35], v[34:35], 1.0 op_sel_hi:[1,0]
    v_pk_add_f32 v[36:37], v[36:37], 1.0 op_sel_hi:[1,0]
    v_pk_add_f32 v[38:39], v[38:39], 1.0 op_sel_hi:[1,0]
    v_pk_add_f32 v[40:41], v[40:41], 1.0 op_sel_hi:[1,0]
    v_pk_add_f32 v[42:43], v[42:43], 1.0 op_sel_hi:[1,0]
    v_pk_add_f32 v[44:45], v[44:45], 1.0 op_sel_hi:[1,0]
    v_pk_add_f32 v[46:47], v[46:47], 1.0 op_sel_hi:[1,0]
    v_mfma_f32_32x32x16_bf16 v[64:79], v[164:167], v[184:187], v[64:79]
    v_rcp_f32 v32, v32
    v_rcp_f32 v33, v33
    v_rcp_f32 v34, v34
    v_rcp_f32 v35, v35
    v_mfma_f32_32x32x16_bf16 v[64:79], v[168:171], v[188:191], v[64:79]
    v_rcp_f32 v36, v36
    v_rcp_f32 v37, v37
    v_rcp_f32 v38, v38
    v_rcp_f32_e64 v39, v39
    s_waitcnt vmcnt(4)
    ds_read_b128 v[172:175], v227 offset:2048
    v_rcp_f32_e64 v40, v40
    ds_read_b128 v[176:179], v228 offset:2048
    v_rcp_f32_e64 v41, v41
    ds_read_b128 v[180:183], v224 offset:12288
    v_rcp_f32_e64 v42, v42
    ds_read_b32 v220, v226 offset:896
    v_rcp_f32_e64 v43, v43
    ds_read_b32 v222, v226 offset:960
    v_rcp_f32_e64 v44, v44
    ds_read_b128 v[184:187], v225 offset:7168
    v_rcp_f32_e64 v45, v45
    ds_read_b128 v[188:191], v225 offset:8192
    v_rcp_f32 v46, v46
    v_rcp_f32 v47, v47
    v_pk_mul_f32 v[32:33], v[32:33], v[48:49]
    v_pk_mul_f32 v[34:35], v[34:35], v[50:51]
    v_pk_mul_f32 v[36:37], v[36:37], v[52:53]
    v_pk_mul_f32 v[38:39], v[38:39], v[54:55]
    v_pk_mul_f32 v[40:41], v[40:41], v[56:57]
    v_pk_mul_f32 v[42:43], v[42:43], v[58:59]
    v_pk_mul_f32 v[44:45], v[44:45], v[60:61]
    v_pk_mul_f32 v[46:47], v[46:47], v[62:63]
    v_cvt_pk_bf16_f32 v164, v32, v33
    v_cvt_pk_bf16_f32 v165, v34, v35
    v_cvt_pk_bf16_f32 v166, v36, v37
    v_cvt_pk_bf16_f32 v167, v38, v39
    v_cvt_pk_bf16_f32 v168, v40, v41
    v_cvt_pk_bf16_f32 v169, v42, v43
    v_cvt_pk_bf16_f32 v170, v44, v45
    v_cvt_pk_bf16_f32 v171, v46, v47
    v_add_u32 v224, 9216, v224
    v_add_u32 v225, 9216, v225
    v_add_u32 v226, 384, v226
    s_bitcmp1_b32 s82, s83
    s_cbranch_scc1 K_EV2
    s_add_u32 s83, s83, 1
    s_branch K_FULL0
K_EV0:
    s_add_u32 s83, s83, 1
    s_bitcmp1_b32 s57, s83
    s_cbranch_scc1 K_LAST1
    s_bitcmp1_b32 s58, s83
    s_cbranch_scc1 K_LASTH1
    s_bitcmp1_b32 s56, s83
    s_cbranch_scc0 K_GENEV0
    s_swappc_b64 s[90:91], s[60:61]
K_FULLF1:
    s_waitcnt lgkmcnt(0)
    v_mfma_f32_32x32x16_bf16 v[48:63], v[180:183], v[200:203], 0
    v_cvt_pk_bf16_f32 v232, v64, v65
    v_cvt_pk_bf16_f32 v233, v66, v67
    v_cvt_pk_bf16_f32 v234, v68, v69
    v_cvt_pk_bf16_f32 v235, v70, v71
    v_cvt_pk_bf16_f32 v236, v72, v73
    v_cvt_pk_bf16_f32 v237, v74, v75
    v_cvt_pk_bf16_f32 v238, v76, v77
    v_cvt_pk_bf16_f32 v239, v78, v79
    v_mfma_f32_32x32x16_bf16 v[48:63], v[172:175], v[192:195], v[48:63]
    v_exp_f32 v16, v32
    s_add_u32 m0, s87, 4096
    v_exp_f32_e64 v17, v33
    buffer_load_dwordx4 v[220:221], s[28:31], s88 idxen offen lds
    v_exp_f32 v18, v34
    v_exp_f32 v19, v35
    v_mfma_f32_32x32x16_bf16 v[48:63], v[176:179], v[196:199], v[48:63]
    v_exp_f32_e64 v20, v36
    s_add_u32 m0, s87, 5120
    v_exp_f32_e64 v21, v37
    buffer_load_dwordx4 v[222:223], s[28:31], s88 idxen offen lds
    v_exp_f32 v22, v38
    v_exp_f32 v23, v39
    v_mfma_f32_16x16x32_bf16 v[8:11], v[212:215], v[232:235], 0
    v_exp_f32_e64 v24, v40
    ds_write_b64 v229, v[232:233] offset:0
    v_exp_f32_e64 v25, v41
    v_mfma_f32_16x16x32_bf16 v[8:11], v[216:219], v[236:239], v[8:11]
    v_exp_f32_e64 v26, v42
    ds_write_b64 v229, v[234:235] offset:16
    v_exp_f32_e64 v27, v43
    ds_write_b64 v229, v[236:237] offset:32
    v_exp_f32_e64 v28, v44
    ds_write_b64 v229, v[238:239] offset:48
    v_exp_f32 v29, v45
    v_exp_f32 v30, v46
    v_exp_f32_e64 v31, v47
    v_pk_add_f32 v[16:17], v[16:17], 1.0 op_sel_hi:[1,0]
    v_pk_add_f32 v[18:19], v[18:19], 1.0 op_sel_hi:[1,0]
    v_pk_add_f32 v[20:21], v[20:21], 1.0 op_sel_hi:[1,0]
    v_pk_add_f32 v[22:23], v[22:23], 1.0 op_sel_hi:[1,0]
    v_pk_add_f32 v[24:25], v[24:25], 1.0 op_sel_hi:[1,0]
    v_pk_add_f32 v[26:27], v[26:27], 1.0 op_sel_hi:[1,0]
    v_pk_add_f32 v[28:29], v[28:29], 1.0 op_sel_hi:[1,0]
    v_pk_add_f32 v[30:31], v[30:31], 1.0 op_sel_hi:[1,0]
    v_mfma_f32_32x32x16_bf16 v[64:79], v[164:167], v[184:187], 0
    v_rcp_f32_e64 v16, v16
    ds_write_b64 v230, v[8:9]
    v_rcp_f32_e64 v17, v17
    v_add_u32 v229, 4224, v229
    v_rcp_f32_e64 v18, v18
    v_add_u32 v230, 128, v230
    v_rcp_f32_e64 v19, v19
    v_mfma_f32_32x32x16_bf16 v[64:79], v[168:171], v[188:191], v[64:79]
    v_rcp_f32 v20, v20
    v_rcp_f32 v21, v21
    v_rcp_f32 v22, v22
    v_rcp_f32_e64 v23, v23
    s_waitcnt vmcnt(4)
    ds_read_b128 v[172:175], v227 offset:0
    v_rcp_f32_e64 v24, v24
    ds_read_b128 v[176:179], v228 offset:0
    v_rcp_f32_e64 v25, v25
    ds_read_b128 v[180:183], v224 offset:9216
    v_rcp_f32_e64 v26, v26
    ds_read_b32 v220, v226 offset:768
    v_rcp_f32_e64 v27, v27
    ds_read_b32 v222, v226 offset:832
    v_rcp_f32_e64 v28, v28
    ds_read_b128 v[184:187], v225 offset:4096
    v_rcp_f32_e64 v29, v29
    ds_read_b128 v[188:191], v225 offset:5120
    v_rcp_f32 v30, v30
    v_rcp_f32 v31, v31
    v_pk_mul_f32 v[16:17], v[16:17], v[32:33]
    v_pk_mul_f32 v[18:19], v[18:19], v[34:35]
    v_pk_mul_f32 v[20:21], v[20:21], v[36:37]
    v_pk_mul_f32 v[22:23], v[22:23], v[38:39]
    v_pk_mul_f32 v[24:25], v[24:25], v[40:41]
    v_pk_mul_f32 v[26:27], v[26:27], v[42:43]
    v_pk_mul_f32 v[28:29], v[28:29], v[44:45]
    v_pk_mul_f32 v[30:31], v[30:31], v[46:47]
    v_cvt_pk_bf16_f32 v164, v16, v17
    v_cvt_pk_bf16_f32 v165, v18, v19
    v_cvt_pk_bf16_f32 v166, v20, v21
    v_cvt_pk_bf16_f32 v167, v22, v23
    v_cvt_pk_bf16_f32 v168, v24, v25
    v_cvt_pk_bf16_f32 v169, v26, v27
    v_cvt_pk_bf16_f32 v170, v28, v29
    v_cvt_pk_bf16_f32 v171, v30, v31
    s_bitcmp1_b32 s82, s83
    s_cbranch_scc1 K_EV1
    s_add_u32 s83, s83, 1
    s_branch K_FULL2
K_EV1:
    s_add_u32 s83, s83, 1
    s_bitcmp1_b32 s57, s83
    s_cbranch_scc1 K_LAST2
    s_bitcmp1_b32 s58, s83
    s_cbranch_scc1 K_LASTH2
    s_bitcmp1_b32 s56, s83
    s_cbranch_scc0 K_GENEV1
    s_swappc_b64 s[90:91], s[60:61]
K_FULLF2:
    s_cmp_ge_u32 s3, 4
    s_cbranch_scc1 K_PR3
    s_setprio 0
K_PR3:
    s_waitcnt lgkmcnt(0)
    v_mfma_f32_32x32x16_bf16 v[16:31], v[180:183], v[200:203], 0
    v_cvt_pk_bf16_f32 v232, v64, v65
    v_cvt_pk_bf16_f32 v233, v66, v67
    v_cvt_pk_bf16_f32 v234, v68, v69
    v_cvt_pk_bf16_f32 v235, v70, v71
    v_cvt_pk_bf16_f32 v236, v72, v73
    v_cvt_pk_bf16_f32 v237, v74, v75
    v_cvt_pk_bf16_f32 v238, v76, v77
    v_cvt_pk_bf16_f32 v239, v78, v79
    v_mfma_f32_32x32x16_bf16 v[16:31], v[172:175], v[192:195], v[16:31]
    v_exp_f32 v32, v48
    s_add_u32 m0, s87, 0
    v_exp_f32_e64 v33, v49
    buffer_load_dwordx4 v[220:221], s[28:31], s88 idxen offen lds
    v_exp_f32 v34, v50
    v_exp_f32 v35, v51
    v_mfma_f32_32x32x16_bf16 v[16:31], v[176:179], v[196:199], v[16:31]
    v_exp_f32_e64 v36, v52
    s_add_u32 m0, s87, 1024
    v_exp_f32_e64 v37, v53
    buffer_load_dwordx4 v[222:223], s[28:31], s88 idxen offen lds
    v_exp_f32 v38, v54
    v_exp_f32 v39, v55
    v_mfma_f32_16x16x32_bf16 v[8:11], v[212:215], v[232:235], 0
    v_exp_f32_e64 v40, v56
    ds_write_b64 v229, v[232:233] offset:0
    v_exp_f32_e64 v41, v57
    v_mfma_f32_16x16x32_bf16 v[8:11], v[216:219], v[236:239], v[8:11]
    v_exp_f32_e64 v42, v58
    ds_write_b64 v229, v[234:235] offset:16
    v_exp_f32_e64 v43, v59
    ds_write_b64 v229, v[236:237] offset:32
    v_exp_f32_e64 v44, v60
    ds_write_b64 v229, v[238:239] offset:48
    v_exp_f32 v45, v61
    v_exp_f32 v46, v62
    v_exp_f32_e64 v47, v63
    v_pk_add_f32 v[32:33], v[32:33], 1.0 op_sel_hi:[1,0]
    v_pk_add_f32 v[34:35], v[34:35], 1.0 op_sel_hi:[1,0]
    v_pk_add_f32 v[36:37], v[36:37], 1.0 op_sel_hi:[1,0]
    v_pk_add_f32 v[38:39], v[38:39], 1.0 op_sel_hi:[1,0]
    v_pk_add_f32 v[40:41], v[40:41], 1.0 op_sel_hi:[1,0]
    v_pk_add_f32 v[42:43], v[42:43], 1.0 op_sel_hi:[1,0]
    v_pk_add_f32 v[44:45], v[44:45], 1.0 op_sel_hi:[1,0]
    v_pk_add_f32 v[46:47], v[46:47], 1.0 op_sel_hi:[1,0]
    v_mfma_f32_32x32x16_bf16 v[64:79], v[164:167], v[184:187], 0
    v_rcp_f32_e64 v32, v32
    ds_write_b64 v230, v[8:9]
    v_rcp_f32_e64 v33, v33
    v_add_u32 v229, 4224, v229
    v_rcp_f32_e64 v34, v34
    v_add_u32 v230, 128, v230
    v_rcp_f32_e64 v35, v35
    v_mfma_f32_32x32x16_bf16 v[64:79], v[168:171], v[188:191], v[64:79]
    v_rcp_f32 v36, v36
    v_rcp_f32 v37, v37
    v_rcp_f32 v38, v38
    v_rcp_f32_e64 v39, v39
    s_waitcnt vmcnt(4)
    ds_read_b128 v[172:175], v227 offset:2048
    v_rcp_f32_e64 v40, v40
    ds_read_b128 v[176:179], v228 offset:2048
    v_rcp_f32_e64 v41, v41
    ds_read_b128 v[180:183], v224 offset:12288
    v_rcp_f32_e64 v42, v42
    ds_read_b32 v220, v226 offset:896
    v_rcp_f32_e64 v43, v43
    ds_read_b32 v222, v226 offset:960
    v_rcp_f32_e64 v44, v44
    ds_read_b128 v[184:187], v225 offset:7168
    v_rcp_f32_e64 v45, v45
    ds_read_b128 v[188:191], v225 offset:8192
    v_rcp_f32 v46, v46
    v_rcp_f32 v47, v47
    v_pk_mul_f32 v[32:33], v[32:33], v[48:49]
    v_pk_mul_f32 v[34:35], v[34:35], v[50:51]
    v_pk_mul_f32 v[36:37], v[36:37], v[52:53]
    v_pk_mul_f32 v[38:39], v[38:39], v[54:55]
    v_pk_mul_f32 v[40:41], v[40:41], v[56:57]
    v_pk_mul_f32 v[42:43], v[42:43], v[58:59]
    v_pk_mul_f32 v[44:45], v[44:45], v[60:61]
    v_pk_mul_f32 v[46:47], v[46:47], v[62:63]
    v_cvt_pk_bf16_f32 v164, v32, v33
    v_cvt_pk_bf16_f32 v165, v34, v35
    v_cvt_pk_bf16_f32 v166, v36, v37
    v_cvt_pk_bf16_f32 v167, v38, v39
    v_cvt_pk_bf16_f32 v168, v40, v41
    v_cvt_pk_bf16_f32 v169, v42, v43
    v_cvt_pk_bf16_f32 v170, v44, v45
    v_cvt_pk_bf16_f32 v171, v46, v47
    v_add_u32 v224, 9216, v224
    v_add_u32 v225, 9216, v225
    v_add_u32 v226, 384, v226
    s_bitcmp1_b32 s82, s83
    s_cbranch_scc1 K_EV2
    s_add_u32 s83, s83, 1
    s_branch K_FULL0
K_EV2:
    s_add_u32 s83, s83, 1
    s_bitcmp1_b32 s57, s83
    s_cbranch_scc1 K_LAST0
    s_bitcmp1_b32 s58, s83
    s_cbranch_scc1 K_LASTH0
    s_bitcmp1_b32 s56, s83
    s_cbranch_scc0 K_GENEV2
    s_swappc_b64 s[90:91], s[60:61]
K_FULLF0:
    s_cmp_ge_u32 s3, 4
    s_cbranch_scc1 K_PR4
    s_setprio 2
K_PR4:
    s_waitcnt lgkmcnt(0)
    v_mfma_f32_32x32x16_bf16 v[32:47], v[180:183], v[200:203], 0
    v_cvt_pk_bf16_f32 v232, v64, v65
    v_cvt_pk_bf16_f32 v233, v66, v67
    v_cvt_pk_bf16_f32 v234, v68, v69
    v_cvt_pk_bf16_f32 v235, v70, v71
    v_cvt_pk_bf16_f32 v236, v72, v73
    v_cvt_pk_bf16_f32 v237, v74, v75
    v_cvt_pk_bf16_f32 v238, v76, v77
    v_cvt_pk_bf16_f32 v239, v78, v79
    v_mfma_f32_32x32x16_bf16 v[32:47], v[172:175], v[192:195], v[32:47]
    v_exp_f32_e64 v48, v16
    s_add_u32 m0, s87, 2048
    v_exp_f32_e64 v49, v17
    buffer_load_dwordx4 v[220:221], s[28:31], s88 idxen offen lds
    v_exp_f32 v50, v18
    v_exp_f32 v51, v19
    v_mfma_f32_32x32x16_bf16 v[32:47], v[176:179], v[196:199], v[32:47]
    v_exp_f32_e64 v52, v20
    s_add_u32 m0, s87, 3072
    v_exp_f32_e64 v53, v21
    buffer_load_dwordx4 v[222:223], s[28:31], s88 idxen offen lds
    v_exp_f32 v54, v22
    v_exp_f32 v55, v23
    v_mfma_f32_16x16x32_bf16 v[8:11], v[212:215], v[232:235], 0
    v_exp_f32_e64 v56, v24
    ds_write_b64 v229, v[232:233] offset:0
    v_exp_f32_e64 v57, v25
    v_mfma_f32_16x16x32_bf16 v[8:11], v[216:219], v[236:239], v[8:11]
    v_exp_f32_e64 v58, v26
    ds_write_b64 v229, v[234:235] offset:16
    v_exp_f32_e64 v59, v27
    ds_write_b64 v229, v[236:237] offset:32
    v_exp_f32_e64 v60, v28
    ds_write_b64 v229, v[238:239] offset:48
    v_exp_f32 v61, v29
    v_exp_f32 v62, v30
    v_exp_f32_e64 v63, v31
    v_pk_add_f32 v[48:49], v[48:49], 1.0 op_sel_hi:[1,0]
    v_pk_add_f32 v[50:51], v[50:51], 1.0 op_sel_hi:[1,0]
    v_pk_add_f32 v[52:53], v[52:53], 1.0 op_sel_hi:[1,0]
    v_pk_add_f32 v[54:55], v[54:55], 1.0 op_sel_hi:[1,0]
    v_pk_add_f32 v[56:57], v[56:57], 1.0 op_sel_hi:[1,0]
    v_pk_add_f32 v[58:59], v[58:59], 1.0 op_sel_hi:[1,0]
    v_pk_add_f32 v[60:61], v[60:61], 1.0 op_sel_hi:[1,0]
    v_pk_add_f32 v[62:63], v[62:63], 1.0 op_sel_hi:[1,0]
    v_mfma_f32_32x32x16_bf16 v[64:79], v[164:167], v[184:187], 0
    v_rcp_f32_e64 v48, v48
    ds_write_b64 v230, v[8:9]
    v_rcp_f32_e64 v49, v49
    v_add_u32 v229, 4224, v229
    v_rcp_f32_e64 v50, v50
    v_add_u32 v230, 128, v230
    v_rcp_f32_e64 v51, v51
    v_mfma_f32_32x32x16_bf16 v[64:79], v[168:171], v[188:191], v[64:79]
    v_rcp_f32 v52, v52
    v_rcp_f32 v53, v53
    v_rcp_f32 v54, v54
    v_rcp_f32_e64 v55, v55
    s_waitcnt vmcnt(4)
    ds_read_b128 v[172:175], v227 offset:4096
    v_rcp_f32_e64 v56, v56
    ds_read_b128 v[176:179], v228 offset:4096
    v_rcp_f32_e64 v57, v57
    ds_read_b128 v[180:183], v224 offset:6144
    v_rcp_f32_e64 v58, v58
    ds_read_b32 v220, v226 offset:640
    v_rcp_f32_e64 v59, v59
    ds_read_b32 v222, v226 offset:704
    v_rcp_f32_e64 v60, v60
    ds_read_b128 v[184:187], v225 offset:1024
    v_rcp_f32_e64 v61, v61
    ds_read_b128 v[188:191], v225 offset:2048
    v_rcp_f32 v62, v62
    v_rcp_f32 v63, v63
    v_pk_mul_f32 v[48:49], v[48:49], v[16:17]
    v_pk_mul_f32 v[50:51], v[50:51], v[18:19]
    v_pk_mul_f32 v[52:53], v[52:53], v[20:21]
    v_pk_mul_f32 v[54:55], v[54:55], v[22:23]
    v_pk_mul_f32 v[56:57], v[56:57], v[24:25]
    v_pk_mul_f32 v[58:59], v[58:59], v[26:27]
    v_pk_mul_f32 v[60:61], v[60:61], v[28:29]
    v_pk_mul_f32 v[62:63], v[62:63], v[30:31]
    v_cvt_pk_bf16_f32 v164, v48, v49
    v_cvt_pk_bf16_f32 v165, v50, v51
    v_cvt_pk_bf16_f32 v166, v52, v53
    v_cvt_pk_bf16_f32 v167, v54, v55
    v_cvt_pk_bf16_f32 v168, v56, v57
    v_cvt_pk_bf16_f32 v169, v58, v59
    v_cvt_pk_bf16_f32 v170, v60, v61
    v_cvt_pk_bf16_f32 v171, v62, v63
    s_bitcmp1_b32 s82, s83
    s_cbranch_scc1 K_EV0
    s_add_u32 s83, s83, 1
    s_branch K_FULL1
K_LAST0:
    v_mov_b64 v[200:201], v[204:205]
    v_mov_b64 v[204:205], v[206:207]
    v_mov_b64 v[206:207], v[208:209]
    v_mov_b64 v[208:209], v[210:211]
    s_branch K_FULL0
K_LASTH0:
    v_mov_b64 v[200:201], v[204:205]
    v_mov_b64 v[204:205], v[206:207]
    v_mov_b64 v[206:207], v[208:209]
    v_mov_b64_e64 v[208:209], v[210:211]
K_HALF0:
    s_cmp_ge_u32 s3, 4
    s_cbranch_scc1 K_PR5
    s_setprio 2
K_PR5:
    s_waitcnt lgkmcnt(0)
    v_mfma_f32_32x32x16_bf16 v[32:47], v[180:183], v[200:203], 0
    v_exp_f32_e64 v48, v16
    s_add_u32 m0, s87, 2048
    v_exp_f32_e64 v49, v17
    buffer_load_dwordx4 v[220:221], s[28:31], s88 idxen offen lds
    v_exp_f32 v50, v18
    v_exp_f32 v51, v19
    v_mfma_f32_32x32x16_bf16 v[32:47], v[172:175], v[192:195], v[32:47]
    v_exp_f32_e64 v52, v20
    s_add_u32 m0, s87, 3072
    v_exp_f32_e64 v53, v21
    buffer_load_dwordx4 v[222:223], s[28:31], s88 idxen offen lds
    v_exp_f32 v54, v22
    v_exp_f32 v55, v23
    v_pk_add_f32 v[48:49], v[48:49], 1.0 op_sel_hi:[1,0]
    v_pk_add_f32 v[50:51], v[50:51], 1.0 op_sel_hi:[1,0]
    v_pk_add_f32 v[52:53], v[52:53], 1.0 op_sel_hi:[1,0]
    v_pk_add_f32 v[54:55], v[54:55], 1.0 op_sel_hi:[1,0]
    v_mfma_f32_32x32x16_bf16 v[32:47], v[176:179], v[196:199], v[32:47]
    v_rcp_f32 v48, v48
    v_rcp_f32 v49, v49
    v_rcp_f32 v50, v50
    v_rcp_f32 v51, v51
    v_mfma_f32_32x32x16_bf16 v[64:79], v[164:167], v[184:187], v[64:79]
    v_rcp_f32 v52, v52
    v_rcp_f32 v53, v53
    v_rcp_f32 v54, v54
    v_rcp_f32_e64 v55, v55
    s_waitcnt vmcnt(4)
    ds_read_b128 v[172:175], v227 offset:4096
    ds_read_b128 v[176:179], v228 offset:4096
    ds_read_b128 v[180:183], v224 offset:6144
    ds_read_b32 v220, v226 offset:640
    ds_read_b32 v222, v226 offset:704
    v_pk_mul_f32 v[48:49], v[48:49], v[16:17]
    v_pk_mul_f32 v[50:51], v[50:51], v[18:19]
    v_pk_mul_f32 v[52:53], v[52:53], v[20:21]
    v_pk_mul_f32 v[54:55], v[54:55], v[22:23]
    v_mfma_f32_32x32x16_bf16 v[64:79], v[168:171], v[188:191], v[64:79]
    v_cvt_pk_bf16_f32 v164, v48, v49
    v_cvt_pk_bf16_f32 v165, v50, v51
    v_cvt_pk_bf16_f32 v166, v52, v53
    v_cvt_pk_bf16_f32 v167, v54, v55
    v_mov_b64 v[168:169], 0
    v_mov_b64 v[170:171], 0
    ds_read_b128 v[184:187], v225 offset:1024
    ds_read_b128 v[188:191], v225 offset:2048
    s_bitcmp1_b32 s82, s83
    s_cbranch_scc1 K_EV0
    s_add_u32 s83, s83, 1
    s_branch K_FULL1
K_LAST1:
    v_mov_b64 v[200:201], v[204:205]
    v_mov_b64 v[204:205], v[206:207]
    v_mov_b64 v[206:207], v[208:209]
    v_mov_b64 v[208:209], v[210:211]
    s_branch K_FULL1
K_LASTH1:
    v_mov_b64 v[200:201], v[204:205]
    v_mov_b64 v[204:205], v[206:207]
    v_mov_b64 v[206:207], v[208:209]
    v_mov_b64 v[208:209], v[210:211]
K_HALF1:
    s_waitcnt lgkmcnt(0)
    v_mfma_f32_32x32x16_bf16 v[48:63], v[180:183], v[200:203], 0
    v_exp_f32_e64 v16, v32
    s_add_u32 m0, s87, 4096
    v_exp_f32_e64 v17, v33
    buffer_load_dwordx4 v[220:221], s[28:31], s88 idxen offen lds
    v_exp_f32 v18, v34
    v_exp_f32 v19, v35
    v_mfma_f32_32x32x16_bf16 v[48:63], v[172:175], v[192:195], v[48:63]
    v_exp_f32_e64 v20, v36
    s_add_u32 m0, s87, 5120
    v_exp_f32_e64 v21, v37
    buffer_load_dwordx4 v[222:223], s[28:31], s88 idxen offen lds
    v_exp_f32 v22, v38
    v_exp_f32 v23, v39
    v_pk_add_f32 v[16:17], v[16:17], 1.0 op_sel_hi:[1,0]
    v_pk_add_f32 v[18:19], v[18:19], 1.0 op_sel_hi:[1,0]
    v_pk_add_f32 v[20:21], v[20:21], 1.0 op_sel_hi:[1,0]
    v_pk_add_f32 v[22:23], v[22:23], 1.0 op_sel_hi:[1,0]
    v_mfma_f32_32x32x16_bf16 v[48:63], v[176:179], v[196:199], v[48:63]
    v_rcp_f32 v16, v16
    v_rcp_f32 v17, v17
    v_rcp_f32 v18, v18
    v_rcp_f32 v19, v19
    v_mfma_f32_32x32x16_bf16 v[64:79], v[164:167], v[184:187], v[64:79]
    v_rcp_f32 v20, v20
    v_rcp_f32 v21, v21
    v_rcp_f32 v22, v22
    v_rcp_f32_e64 v23, v23
    s_waitcnt vmcnt(4)
    ds_read_b128 v[172:175], v227 offset:0
    ds_read_b128 v[176:179], v228 offset:0
    ds_read_b128 v[180:183], v224 offset:9216
    ds_read_b32 v220, v226 offset:768
    ds_read_b32 v222, v226 offset:832
    v_pk_mul_f32 v[16:17], v[16:17], v[32:33]
    v_pk_mul_f32 v[18:19], v[18:19], v[34:35]
    v_pk_mul_f32 v[20:21], v[20:21], v[36:37]
    v_pk_mul_f32 v[22:23], v[22:23], v[38:39]
    v_mfma_f32_32x32x16_bf16 v[64:79], v[168:171], v[188:191], v[64:79]
    v_cvt_pk_bf16_f32 v164, v16, v17
    v_cvt_pk_bf16_f32 v165, v18, v19
    v_cvt_pk_bf16_f32 v166, v20, v21
    v_cvt_pk_bf16_f32 v167, v22, v23
    v_mov_b64 v[168:169], 0
    v_mov_b64 v[170:171], 0
    ds_read_b128 v[184:187], v225 offset:4096
    ds_read_b128 v[188:191], v225 offset:5120
    s_bitcmp1_b32 s82, s83
    s_cbranch_scc1 K_EV1
    s_add_u32 s83, s83, 1
    s_branch K_FULL2
K_LAST2:
    v_mov_b64 v[200:201], v[204:205]
    v_mov_b64 v[204:205], v[206:207]
    v_mov_b64 v[206:207], v[208:209]
    v_mov_b64 v[208:209], v[210:211]
    s_branch K_FULL2
K_LASTH2:
    v_mov_b64 v[200:201], v[204:205]
    v_mov_b64 v[204:205], v[206:207]
    v_mov_b64 v[206:207], v[208:209]
    v_mov_b64_e64 v[208:209], v[210:211]
K_HALF2:
    s_cmp_ge_u32 s3, 4
    s_cbranch_scc1 K_PR6
    s_setprio 0
K_PR6:
    s_waitcnt lgkmcnt(0)
    v_mfma_f32_32x32x16_bf16 v[16:31], v[180:183], v[200:203], 0
    v_exp_f32 v32, v48
    s_add_u32 m0, s87, 0
    v_exp_f32_e64 v33, v49
    buffer_load_dwordx4 v[220:221], s[28:31], s88 idxen offen lds
    v_exp_f32 v34, v50
    v_exp_f32 v35, v51
    v_mfma_f32_32x32x16_bf16 v[16:31], v[172:175], v[192:195], v[16:31]
    v_exp_f32_e64 v36, v52
    s_add_u32 m0, s87, 1024
    v_exp_f32_e64 v37, v53
    buffer_load_dwordx4 v[222:223], s[28:31], s88 idxen offen lds
    v_exp_f32 v38, v54
    v_exp_f32 v39, v55
    v_pk_add_f32 v[32:33], v[32:33], 1.0 op_sel_hi:[1,0]
    v_pk_add_f32 v[34:35], v[34:35], 1.0 op_sel_hi:[1,0]
    v_pk_add_f32 v[36:37], v[36:37], 1.0 op_sel_hi:[1,0]
    v_pk_add_f32 v[38:39], v[38:39], 1.0 op_sel_hi:[1,0]
    v_mfma_f32_32x32x16_bf16 v[16:31], v[176:179], v[196:199], v[16:31]
    v_rcp_f32 v32, v32
    v_rcp_f32 v33, v33
    v_rcp_f32 v34, v34
    v_rcp_f32 v35, v35
    v_mfma_f32_32x32x16_bf16 v[64:79], v[164:167], v[184:187], v[64:79]
    v_rcp_f32 v36, v36
    v_rcp_f32 v37, v37
    v_rcp_f32 v38, v38
    v_rcp_f32_e64 v39, v39
    s_waitcnt vmcnt(4)
    ds_read_b128 v[172:175], v227 offset:2048
    ds_read_b128 v[176:179], v228 offset:2048
    ds_read_b128 v[180:183], v224 offset:12288
    ds_read_b32 v220, v226 offset:896
    ds_read_b32 v222, v226 offset:960
    v_pk_mul_f32 v[32:33], v[32:33], v[48:49]
    v_pk_mul_f32 v[34:35], v[34:35], v[50:51]
    v_pk_mul_f32 v[36:37], v[36:37], v[52:53]
    v_pk_mul_f32 v[38:39], v[38:39], v[54:55]
    v_mfma_f32_32x32x16_bf16 v[64:79], v[168:171], v[188:191], v[64:79]
    v_cvt_pk_bf16_f32 v164, v32, v33
    v_cvt_pk_bf16_f32 v165, v34, v35
    v_cvt_pk_bf16_f32 v166, v36, v37
    v_cvt_pk_bf16_f32 v167, v38, v39
    v_mov_b64 v[168:169], 0
    v_mov_b64 v[170:171], 0
    ds_read_b128 v[184:187], v225 offset:7168
    ds_read_b128 v[188:191], v225 offset:8192
    v_add_u32 v224, 9216, v224
    v_add_u32 v225, 9216, v225
    v_add_u32 v226, 384, v226
    s_bitcmp1_b32 s82, s83
    s_cbranch_scc1 K_EV2
    s_add_u32 s83, s83, 1
    s_branch K_FULL0
K_GENEV0:
    s_add_u32 s93, s83, 1
    s_bitcmp1_b32 s80, s93
    s_cbranch_scc0 K_GA0
    v_mov_b64 v[200:201], v[204:205]
    v_mov_b64 v[204:205], v[206:207]
    v_mov_b64 v[206:207], v[208:209]
    v_mov_b64 v[208:209], v[210:211]
K_GA0:
    s_sub_u32 s93, s83, 1
    s_bitcmp1_b32 s79, s93
    s_cbranch_scc0 K_GB0
    s_call_b64 s[90:91], K_FLUSH
K_GB0:
    s_cmp_eq_u32 s83, s84
    s_cbranch_scc1 K_DRAIN
    s_bitcmp1_b32 s81, s83
    s_cbranch_scc0 K_FULL1
    s_branch K_HALF1
K_GENEV1:
    s_add_u32 s93, s83, 1
    s_bitcmp1_b32 s80, s93
    s_cbranch_scc0 K_GA1
    v_mov_b64 v[200:201], v[204:205]
    v_mov_b64 v[204:205], v[206:207]
    v_mov_b64 v[206:207], v[208:209]
    v_mov_b64 v[208:209], v[210:211]
K_GA1:
    s_sub_u32 s93, s83, 1
    s_bitcmp1_b32 s79, s93
    s_cbranch_scc0 K_GB1
    s_call_b64 s[90:91], K_FLUSH
K_GB1:
    s_cmp_eq_u32 s83, s84
    s_cbranch_scc1 K_DRAIN
    s_bitcmp1_b32 s81, s83
    s_cbranch_scc0 K_FULL2
    s_branch K_HALF2
K_GENEV2:
    s_add_u32 s93, s83, 1
    s_bitcmp1_b32 s80, s93
    s_cbranch_scc0 K_GA2
    v_mov_b64 v[200:201], v[204:205]
    v_mov_b64 v[204:205], v[206:207]
    v_mov_b64 v[206:207], v[208:209]
    v_mov_b64_e64 v[208:209], v[210:211]
K_GA2:
    s_sub_u32 s93, s83, 1
    s_bitcmp1_b32 s79, s93
    s_cbranch_scc0 K_GB2
    s_call_b64 s[90:91], K_FLUSH
K_GB2:
    s_cmp_eq_u32 s83, s84
    s_cbranch_scc1 K_DRAIN
    s_bitcmp1_b32 s81, s83
    s_cbranch_scc0 K_FULL0
    s_branch K_HALF0
K_FLUSH:
    s_nop 3
    v_cvt_pk_bf16_f32 v232, v64, v65
    v_cvt_pk_bf16_f32 v233, v66, v67
    v_cvt_pk_bf16_f32 v234, v68, v69
    v_cvt_pk_bf16_f32 v235, v70, v71
    v_cvt_pk_bf16_f32 v236, v72, v73
    v_cvt_pk_bf16_f32 v237, v74, v75
    v_cvt_pk_bf16_f32 v238, v76, v77
    v_cvt_pk_bf16_f32 v239, v78, v79
    v_mfma_f32_16x16x32_bf16 v[8:11], v[212:215], v[232:235], 0
    s_nop 0
    v_mfma_f32_16x16x32_bf16 v[8:11], v[216:219], v[236:239], v[8:11]
    ds_write_b64 v229, v[232:233] offset:0
    ds_write_b64 v229, v[234:235] offset:16
    ds_write_b64 v229, v[236:237] offset:32
    ds_write_b64 v229, v[238:239] offset:48
    v_mov_b64 v[64:65], 0
    v_mov_b64 v[66:67], 0
    v_mov_b64 v[68:69], 0
    v_mov_b64 v[70:71], 0
    v_mov_b64 v[72:73], 0
    v_mov_b64 v[74:75], 0
    v_mov_b64 v[76:77], 0
    v_mov_b64_e64 v[78:79], 0
    ds_write_b64 v230, v[8:9]
    v_add_u32 v229, 4224, v229
    v_add_u32 v230, 128, v230
    s_setpc_b64 s[90:91]
K_WH0:
    s_add_u32 s92, s98, 0
    buffer_load_dwordx4 v[80:83], v248, s[24:27], s92 offen offset:0
    buffer_load_dwordx4 v[84:87], v248, s[24:27], s92 offen offset:1024
    buffer_load_dwordx4 v[88:91], v248, s[24:27], s92 offen offset:2048
    buffer_load_dwordx4 v[92:95], v248, s[24:27], s92 offen offset:3072
    s_add_u32 s86, s86, 1
    s_add_u32 s60, s60, K_WH1-K_WH0
    s_addc_u32 s61, s61, 0
    s_setpc_b64 s[90:91]
K_WH1:
    s_add_u32 s92, s98, 4096
    buffer_load_dwordx4 v[96:99], v248, s[24:27], s92 offen offset:0
    buffer_load_dwordx4 v[100:103], v248, s[24:27], s92 offen offset:1024
    buffer_load_dwordx4 v[104:107], v248, s[24:27], s92 offen offset:2048
    buffer_load_dwordx4 v[108:111], v248, s[24:27], s92 offen offset:3072
    s_add_u32 s86, s86, 1
    s_add_u32 s60, s60, K_WH2-K_WH1
    s_addc_u32 s61, s61, 0
    s_setpc_b64 s[90:91]
K_WH2:
    s_add_u32 s92, s98, 8192
    buffer_load_dwordx4 v[112:115], v248, s[24:27], s92 offen offset:0
    buffer_load_dwordx4 v[116:119], v248, s[24:27], s92 offen offset:1024
    buffer_load_dwordx4 v[120:123], v248, s[24:27], s92 offen offset:2048
    buffer_load_dwordx4 v[124:127], v248, s[24:27], s92 offen offset:3072
    s_add_u32 s86, s86, 1
    s_add_u32 s60, s60, K_WH3-K_WH2
    s_addc_u32 s61, s61, 0
    s_setpc_b64 s[90:91]
K_WH3:
    s_add_u32 s92, s98, 12288
    buffer_load_dwordx4 v[128:131], v248, s[24:27], s92 offen offset:0
    buffer_load_dwordx4 v[132:135], v248, s[24:27], s92 offen offset:1024
    buffer_load_dwordx4 v[136:139], v248, s[24:27], s92 offen offset:2048
    buffer_load_dwordx4 v[140:143], v248, s[24:27], s92 offen offset:3072
    s_add_u32 s86, s86, 1
    s_add_u32 s60, s60, K_WH4-K_WH3
    s_addc_u32 s61, s61, 0
    s_setpc_b64 s[90:91]
K_WH4:
    s_setpc_b64 s[90:91]
K_DRAIN:
    s_waitcnt lgkmcnt(0)
    v_mfma_f32_32x32x16_bf16 v[64:79], v[164:167], v[184:187], v[64:79]
    v_mfma_f32_32x32x16_bf16 v[64:79], v[168:171], v[188:191], v[64:79]
    s_bitcmp1_b32 s89, s84
    s_cbranch_scc0 K_NOFL
    s_nop 7
    s_call_b64 s[90:91], K_FLUSH
K_NOFL:
    s_add_u32 s85, s85, 26
    s_cmp_ge_u32 s85, s78
    s_cbranch_scc1 K_EPI
    s_lshl_b32 s99, s85, 5
    s_waitcnt vmcnt(0) lgkmcnt(0)
    s_barrier
    v_mov_b32 v232, 0
    v_mov_b32 v233, 0
    v_mov_b32 v234, 0
    v_mov_b32 v235, 0
    v_lshlrev_b32_e64 v10, 4, v0
    v_add_u32 v10, 23040, v10
    v_add_u32 v11, 0x10000, v10
    ds_write_b128 v10, v[232:235] offset:0
    ds_write_b128 v10, v[232:235] offset:8192
    ds_write_b128 v10, v[232:235] offset:16384
    ds_write_b128 v10, v[232:235] offset:24576
    ds_write_b128 v10, v[232:235] offset:32768
    ds_write_b128 v10, v[232:235] offset:40960
    ds_write_b128 v10, v[232:235] offset:49152
    ds_write_b128 v10, v[232:235] offset:57344
    ds_write_b128 v11, v[232:235]
    v_cmp_gt_u32 vcc, 384, v0
    s_and_saveexec_b64 s[94:95], vcc
    ds_write_b128 v11, v[232:235] offset:8192
    s_mov_b64 exec, -1
    v_mov_b32 v236, 0x7fff
    v_mov_b32 v237, 0x7fff
    v_lshlrev_b32_e64 v10, 3, v0
    v_add_u32 v10, 108544, v10
    ds_write_b64 v10, v[236:237]
    s_sub_u32 s84, s78, s85
    s_min_u32 s84, s84, 26
    s_mov_b32 s89, 0
    s_mov_b32 s81, 0
    s_sub_u32 s92, s74, s85
    s_lshl_b32 s93, 1, s92
    s_cmp_le_u32 s92, s84
    s_cselect_b32 s93, s93, 0
    s_or_b32 s89, s89, s93
    s_lshr_b32 s93, s93, 1
    s_sub_u32 s94, s68, 1
    s_max_i32 s94, s94, 0
    s_bitcmp0_b32 s94, 4
    s_cselect_b32 s93, s93, 0
    s_or_b32 s81, s81, s93
    s_sub_u32 s92, s75, s85
    s_lshl_b32 s93, 1, s92
    s_cmp_le_u32 s92, s84
    s_cselect_b32 s93, s93, 0
    s_or_b32 s89, s89, s93
    s_lshr_b32 s93, s93, 1
    s_sub_u32 s94, s69, 1
    s_max_i32 s94, s94, 0
    s_bitcmp0_b32 s94, 4
    s_cselect_b32 s93, s93, 0
    s_or_b32 s81, s81, s93
    s_sub_u32 s92, s76, s85
    s_lshl_b32 s93, 1, s92
    s_cmp_le_u32 s92, s84
    s_cselect_b32 s93, s93, 0
    s_or_b32 s89, s89, s93
    s_lshr_b32 s93, s93, 1
    s_sub_u32 s94, s70, 1
    s_max_i32 s94, s94, 0
    s_bitcmp0_b32 s94, 4
    s_cselect_b32 s93, s93, 0
    s_or_b32 s81, s81, s93
    s_sub_u32 s92, s77, s85
    s_lshl_b32 s93, 1, s92
    s_cmp_le_u32 s92, s84
    s_cselect_b32 s93, s93, 0
    s_or_b32 s89, s89, s93
    s_lshr_b32 s93, s93, 1
    s_sub_u32 s94, s71, 1
    s_max_i32 s94, s94, 0
    s_bitcmp0_b32 s94, 4
    s_cselect_b32 s93, s93, 0
    s_or_b32 s81, s81, s93
    s_sub_u32 s92, s78, s85
    s_lshl_b32 s93, 1, s92
    s_cmp_le_u32 s92, s84
    s_cselect_b32 s93, s93, 0
    s_or_b32 s89, s89, s93
    s_lshr_b32 s93, s93, 1
    s_sub_u32 s94, s72, 1
    s_max_i32 s94, s94, 0
    s_bitcmp0_b32 s94, 4
    s_cselect_b32 s93, s93, 0
    s_or_b32 s81, s81, s93
    s_andn2_b32 s79, s89, 1
    s_lshl_b32 s92, 1, s84
    s_andn2_b32 s80, s89, s92
    s_lshr_b32 s92, s92, 1
    s_or_b32 s82, s79, s92
    s_lshr_b32 s92, s80, 2
    s_or_b32 s82, s82, s92
    s_lshr_b32 s92, s81, 1
    s_or_b32 s82, s82, s92
    s_mov_b32 s83, 0
    v_and_b32 v2, 0x33, v1
    v_bfe_u32 v3, v1, 2, 1
    v_lshl_or_b32 v2, v3, 3, v2
    v_bfe_u32 v3, v1, 3, 1
    v_lshl_or_b32 v2, v3, 2, v2
    v_lshlrev_b32_e64 v224, 4, v2
    v_add_u32 v224, 23040, v224
    v_add_u32 v225, 23040, v248
    v_and_b32_e64 v3, 0x3c, v1
    v_add_u32 v226, 108544, v3
    s_mov_b32 s92, 0
    s_waitcnt lgkmcnt(0)
    s_barrier
    s_branch K_GEN
K_EPI:
    s_cmp_ge_u32 s86, 4
    s_cbranch_scc1 K_EPI2
    s_swappc_b64 s[90:91], s[60:61]
    s_branch K_EPI
K_EPI2:
    s_setprio 0
    s_add_u32 s101, s64, 131072
    buffer_load_dwordx4 v[16:19], v248, s[24:27], s101 offen offset:0
    buffer_load_dwordx4 v[20:23], v248, s[24:27], s101 offen offset:1024
    buffer_load_dwordx4 v[24:27], v248, s[24:27], s101 offen offset:2048
    buffer_load_dwordx4 v[28:31], v248, s[24:27], s101 offen offset:3072
    s_add_u32 s101, s64, 135168
    buffer_load_dwordx4 v[32:35], v248, s[24:27], s101 offen offset:0
    buffer_load_dwordx4 v[36:39], v248, s[24:27], s101 offen offset:1024
    s_lshr_b32 s92, s3, 2
    s_lshl_b32 s92, s92, 3
    s_and_b32 s93, s3, 3
    s_add_u32 s92, s92, s93
    v_lshrrev_b32 v12, 5, v1
    v_lshl_add_u32 v3, v12, 2, s92
    v_and_b32 v13, 31, v1
    v_lshlrev_b32 v13, 4, v13
    v_mul_u32_u24 v5, 528, v3
    v_add_u32_e64 v5, v5, v13
    v_lshl_add_u32 v3, v3, 17, v13
    s_lshl_b32 s92, s2, 9
    v_add_u32 v3, s92, v3
    s_mul_i32 s93, s3, 1040
    s_mov_b32 s94, 2097152
    s_mov_b32 s95, 4194304
    s_waitcnt vmcnt(6) lgkmcnt(0)
    s_barrier
    s_add_u32 m0, s93, 47616
    s_nop 0
    buffer_load_dwordx4 v3, s[32:35], 0 offen lds
    s_add_u32 m0, s93, 55936
    s_nop 0
    buffer_load_dwordx4 v3, s[32:35], s94 offen lds
    s_add_u32 m0, s93, 64256
    s_nop 0
    buffer_load_dwordx4 v3, s[32:35], s95 offen lds
    ds_read_b128 v[232:235], v6 offset:0
    ds_read_b128 v[236:239], v7 offset:0
    ds_read_b128 v[240:243], v6 offset:32
    ds_read_b128 v[244:247], v7 offset:32
    ds_read_b128 v[184:187], v6 offset:64
    ds_read_b128 v[188:191], v7 offset:64
    s_waitcnt lgkmcnt(4)
    v_mfma_f32_32x32x16_bf16 v[144:159], v[80:83], v[232:235], 0
    buffer_load_dwordx4 v[40:43], v248, s[24:27], s101 offen offset:2048
    v_lshlrev_b32 v13, 3, v12
    v_sub_u32 v2, v6, v13
    v_mfma_f32_16x16x32_bf16 v[160:163], v[80:83], v[236:239], 0
    ds_read_b128 v[232:235], v6 offset:96
    ds_read_b128 v[236:239], v7 offset:96
    s_waitcnt lgkmcnt(4)
    v_mfma_f32_32x32x16_bf16 v[144:159], v[84:87], v[240:243], v[144:159]
    buffer_load_dwordx4 v[44:47], v248, s[24:27], s101 offen offset:3072
    v_add_u32 v2, s88, v2
    v_sub_u32_e64 v8, v254, v13
    v_mfma_f32_16x16x32_bf16 v[160:163], v[84:87], v[244:247], v[160:163]
    ds_read_b128 v[240:243], v6 offset:128
    ds_read_b128 v[244:247], v7 offset:128
    s_waitcnt lgkmcnt(4)
    v_mfma_f32_32x32x16_bf16 v[144:159], v[88:91], v[184:187], v[144:159]
    s_add_u32 s101, s64, 139264
    buffer_load_dwordx4 v[48:51], v248, s[24:27], s101 offen offset:0
    v_add_u32 v8, s88, v8
    v_and_b32_e64 v4, 3, v1
    v_mfma_f32_16x16x32_bf16 v[160:163], v[88:91], v[188:191], v[160:163]
    ds_read_b128 v[184:187], v6 offset:160
    ds_read_b128 v[188:191], v7 offset:160
    s_waitcnt lgkmcnt(4)
    v_mfma_f32_32x32x16_bf16 v[144:159], v[92:95], v[232:235], v[144:159]
    buffer_load_dwordx4 v[52:55], v248, s[24:27], s101 offen offset:1024
    v_mul_u32_u24 v4, 528, v4
    v_bfe_u32 v13, v1, 3, 1
    v_mfma_f32_16x16x32_bf16 v[160:163], v[92:95], v[236:239], v[160:163]
    ds_read_b128 v[232:235], v6 offset:192
    ds_read_b128 v[236:239], v7 offset:192
    s_waitcnt lgkmcnt(4)
    v_mfma_f32_32x32x16_bf16 v[144:159], v[96:99], v[240:243], v[144:159]
    buffer_load_dwordx4 v[56:59], v248, s[24:27], s101 offen offset:2048
    v_mul_u32_u24 v13, 2112, v13
    v_add3_u32 v4, v4, v13, s88
    v_mfma_f32_16x16x32_bf16 v[160:163], v[96:99], v[244:247], v[160:163]
    ds_read_b128 v[240:243], v6 offset:224
    ds_read_b128 v[244:247], v7 offset:224
    s_waitcnt lgkmcnt(4)
    v_mfma_f32_32x32x16_bf16 v[144:159], v[100:103], v[184:187], v[144:159]
    buffer_load_dwordx4 v[60:63], v248, s[24:27], s101 offen offset:3072
    v_bfe_u32 v13, v1, 2, 1
    v_lshl_add_u32 v4, v13, 5, v4
    v_mfma_f32_16x16x32_bf16 v[160:163], v[100:103], v[188:191], v[160:163]
    ds_read_b128 v[184:187], v6 offset:256
    ds_read_b128 v[188:191], v7 offset:256
    s_waitcnt lgkmcnt(4)
    v_mfma_f32_32x32x16_bf16 v[144:159], v[104:107], v[232:235], v[144:159]
    s_add_u32 s101, s64, 143360
    buffer_load_dwordx4 v[64:67], v248, s[24:27], s101 offen offset:0
    v_lshrrev_b32_e64 v13, 4, v1
    v_lshl_add_u32 v4, v13, 3, v4
    v_mfma_f32_16x16x32_bf16 v[160:163], v[104:107], v[236:239], v[160:163]
    ds_read_b128 v[232:235], v6 offset:288
    ds_read_b128 v[236:239], v7 offset:288
    s_waitcnt lgkmcnt(4)
    v_mfma_f32_32x32x16_bf16 v[144:159], v[108:111], v[240:243], v[144:159]
    buffer_load_dwordx4 v[68:71], v248, s[24:27], s101 offen offset:1024
    v_add_u32 v4, 39936, v4
    v_and_b32 v9, 3, v1
    v_mfma_f32_16x16x32_bf16 v[160:163], v[108:111], v[244:247], v[160:163]
    ds_read_b128 v[240:243], v6 offset:320
    ds_read_b128 v[244:247], v7 offset:320
    s_waitcnt lgkmcnt(4)
    v_mfma_f32_32x32x16_bf16 v[144:159], v[112:115], v[184:187], v[144:159]
    buffer_load_dwordx4 v[72:75], v248, s[24:27], s101 offen offset:2048
    v_mul_u32_u24 v9, 1040, v9
    v_bfe_u32 v13, v1, 3, 1
    v_mfma_f32_16x16x32_bf16 v[160:163], v[112:115], v[188:191], v[160:163]
    ds_read_b128 v[184:187], v6 offset:352
    ds_read_b128 v[188:191], v7 offset:352
    s_waitcnt lgkmcnt(4)
    v_mfma_f32_32x32x16_bf16 v[144:159], v[116:119], v[232:235], v[144:159]
    buffer_load_dwordx4 v[76:79], v248, s[24:27], s101 offen offset:3072
    v_mul_u32_u24 v13, 512, v13
    v_mfma_f32_16x16x32_bf16 v[160:163], v[116:119], v[236:239], v[160:163]
    ds_read_b128 v[232:235], v6 offset:384
    ds_read_b128 v[236:239], v7 offset:384
    s_waitcnt lgkmcnt(4)
    v_mfma_f32_32x32x16_bf16 v[144:159], v[120:123], v[240:243], v[144:159]
    v_add3_u32 v9, v9, v13, s88
    v_mfma_f32_16x16x32_bf16 v[160:163], v[120:123], v[244:247], v[160:163]
    ds_read_b128 v[240:243], v6 offset:416
    ds_read_b128 v[244:247], v7 offset:416
    s_waitcnt lgkmcnt(4)
    v_mfma_f32_32x32x16_bf16 v[144:159], v[124:127], v[184:187], v[144:159]
    v_bfe_u32 v13, v1, 2, 1
    v_mfma_f32_16x16x32_bf16 v[160:163], v[124:127], v[188:191], v[160:163]
    ds_read_b128 v[184:187], v6 offset:448
    ds_read_b128 v[188:191], v7 offset:448
    s_waitcnt lgkmcnt(4)
    v_mfma_f32_32x32x16_bf16 v[144:159], v[128:131], v[232:235], v[144:159]
    v_lshl_add_u32 v9, v13, 5, v9
    v_mfma_f32_16x16x32_bf16 v[160:163], v[128:131], v[236:239], v[160:163]
    ds_read_b128 v[232:235], v6 offset:480
    ds_read_b128 v[236:239], v7 offset:480
    s_waitcnt lgkmcnt(4)
    v_mfma_f32_32x32x16_bf16 v[144:159], v[132:135], v[240:243], v[144:159]
    v_lshrrev_b32_e64 v13, 4, v1
    v_mfma_f32_16x16x32_bf16 v[160:163], v[132:135], v[244:247], v[160:163]
    s_waitcnt lgkmcnt(2)
    v_mfma_f32_32x32x16_bf16 v[144:159], v[136:139], v[184:187], v[144:159]
    v_lshl_add_u32 v9, v13, 3, v9
    v_mfma_f32_16x16x32_bf16 v[160:163], v[136:139], v[188:191], v[160:163]
    s_waitcnt lgkmcnt(0)
    v_mfma_f32_32x32x16_bf16 v[144:159], v[140:143], v[232:235], v[144:159]
    s_waitcnt vmcnt(10)
    s_barrier
    v_add_u32 v9, 64256, v9
    v_mfma_f32_16x16x32_bf16 v[160:163], v[140:143], v[236:239], v[160:163]
    ds_read_b64 v[192:193], v8 offset:47616
    ds_read_b64 v[194:195], v8 offset:47632
    ds_read_b64 v[196:197], v8 offset:47648
    ds_read_b64 v[198:199], v8 offset:47664
    ds_read_b64 v[200:201], v9
    ds_read_b128 v[232:235], v254 offset:47616
    ds_read_b128 v[236:239], v255 offset:47616
    ds_read_b128 v[240:243], v254 offset:47648
    ds_read_b128 v[244:247], v255 offset:47648
    ds_read_b128 v[184:187], v254 offset:47680
    ds_read_b128 v[188:191], v255 offset:47680
    s_waitcnt lgkmcnt(4)
    v_mfma_f32_32x32x16_bf16 v[164:179], v[16:19], v[232:235], 0
    v_lshlrev_b32 v80, 16, v192
    v_and_b32 v81, 0xffff0000, v192
    v_mfma_f32_16x16x32_bf16 v[180:183], v[16:19], v[236:239], 0
    ds_read_b128 v[232:235], v254 offset:47712
    ds_read_b128 v[236:239], v255 offset:47712
    s_waitcnt lgkmcnt(4)
    v_mfma_f32_32x32x16_bf16 v[164:179], v[20:23], v[240:243], v[164:179]
    v_lshlrev_b32 v82, 16, v193
    v_and_b32 v83, 0xffff0000, v193
    v_mfma_f32_16x16x32_bf16 v[180:183], v[20:23], v[244:247], v[180:183]
    ds_read_b128 v[240:243], v254 offset:47744
    ds_read_b128 v[244:247], v255 offset:47744
    s_waitcnt lgkmcnt(4)
    v_mfma_f32_32x32x16_bf16 v[164:179], v[24:27], v[184:187], v[164:179]
    v_lshlrev_b32 v84, 16, v194
    v_and_b32 v85, 0xffff0000, v194
    v_mfma_f32_16x16x32_bf16 v[180:183], v[24:27], v[188:191], v[180:183]
    ds_read_b128 v[184:187], v254 offset:47776
    ds_read_b128 v[188:191], v255 offset:47776
    s_waitcnt lgkmcnt(4)
    v_mfma_f32_32x32x16_bf16 v[164:179], v[28:31], v[232:235], v[164:179]
    v_lshlrev_b32 v86, 16, v195
    v_and_b32 v87, 0xffff0000, v195
    v_mfma_f32_16x16x32_bf16 v[180:183], v[28:31], v[236:239], v[180:183]
    ds_read_b128 v[232:235], v254 offset:47808
    ds_read_b128 v[236:239], v255 offset:47808
    s_waitcnt lgkmcnt(4)
    v_mfma_f32_32x32x16_bf16 v[164:179], v[32:35], v[240:243], v[164:179]
    v_lshlrev_b32 v88, 16, v196
    v_and_b32 v89, 0xffff0000, v196
    v_mfma_f32_16x16x32_bf16 v[180:183], v[32:35], v[244:247], v[180:183]
    ds_read_b128 v[240:243], v254 offset:47840
    ds_read_b128 v[244:247], v255 offset:47840
    s_waitcnt lgkmcnt(4)
    v_mfma_f32_32x32x16_bf16 v[164:179], v[36:39], v[184:187], v[164:179]
    v_lshlrev_b32 v90, 16, v197
    v_and_b32 v91, 0xffff0000, v197
    v_mfma_f32_16x16x32_bf16 v[180:183], v[36:39], v[188:191], v[180:183]
    ds_read_b128 v[184:187], v254 offset:47872
    ds_read_b128 v[188:191], v255 offset:47872
    s_waitcnt vmcnt(9) lgkmcnt(4)
    v_mfma_f32_32x32x16_bf16 v[164:179], v[40:43], v[232:235], v[164:179]
    v_lshlrev_b32 v92, 16, v198
    v_and_b32 v93, 0xffff0000, v198
    v_mfma_f32_16x16x32_bf16 v[180:183], v[40:43], v[236:239], v[180:183]
    ds_read_b128 v[232:235], v254 offset:47904
    ds_read_b128 v[236:239], v255 offset:47904
    s_waitcnt vmcnt(8) lgkmcnt(4)
    v_mfma_f32_32x32x16_bf16 v[164:179], v[44:47], v[240:243], v[164:179]
    v_lshlrev_b32 v94, 16, v199
    v_and_b32 v95, 0xffff0000, v199
    v_mfma_f32_16x16x32_bf16 v[180:183], v[44:47], v[244:247], v[180:183]
    ds_read_b128 v[240:243], v254 offset:47936
    ds_read_b128 v[244:247], v255 offset:47936
    s_waitcnt vmcnt(7) lgkmcnt(4)
    v_mfma_f32_32x32x16_bf16 v[164:179], v[48:51], v[184:187], v[164:179]
    v_lshlrev_b32 v96, 16, v200
    v_and_b32 v97, 0xffff0000, v200
    v_mfma_f32_16x16x32_bf16 v[180:183], v[48:51], v[188:191], v[180:183]
    ds_read_b128 v[184:187], v254 offset:47968
    ds_read_b128 v[188:191], v255 offset:47968
    s_waitcnt vmcnt(6) lgkmcnt(4)
    v_mfma_f32_32x32x16_bf16 v[164:179], v[52:55], v[232:235], v[164:179]
    v_lshlrev_b32 v98, 16, v201
    v_and_b32 v99, 0xffff0000, v201
    v_mfma_f32_16x16x32_bf16 v[180:183], v[52:55], v[236:239], v[180:183]
    ds_read_b128 v[232:235], v254 offset:48000
    ds_read_b128 v[236:239], v255 offset:48000
    s_waitcnt vmcnt(5) lgkmcnt(4)
    v_mfma_f32_32x32x16_bf16 v[164:179], v[56:59], v[240:243], v[164:179]
    v_lshrrev_b32 v3, 2, v1
    v_and_b32_e64 v13, 3, v1
    v_mfma_f32_16x16x32_bf16 v[180:183], v[56:59], v[244:247], v[180:183]
    ds_read_b128 v[240:243], v254 offset:48032
    ds_read_b128 v[244:247], v255 offset:48032
    s_waitcnt vmcnt(4) lgkmcnt(4)
    v_mfma_f32_32x32x16_bf16 v[164:179], v[60:63], v[184:187], v[164:179]
    v_lshlrev_b32 v13, 4, v13
    v_add_u32_e64 v13, s88, v13
    v_mfma_f32_16x16x32_bf16 v[180:183], v[60:63], v[188:191], v[180:183]
    ds_read_b128 v[184:187], v254 offset:48064
    ds_read_b128 v[188:191], v255 offset:48064
    s_waitcnt vmcnt(3) lgkmcnt(4)
    v_mfma_f32_32x32x16_bf16 v[164:179], v[64:67], v[232:235], v[164:179]
    v_mul_u32_u24 v5, 528, v3
    v_mfma_f32_16x16x32_bf16 v[180:183], v[64:67], v[236:239], v[180:183]
    ds_read_b128 v[232:235], v254 offset:48096
    ds_read_b128 v[236:239], v255 offset:48096
    s_waitcnt vmcnt(2) lgkmcnt(4)
    v_mfma_f32_32x32x16_bf16 v[164:179], v[68:71], v[240:243], v[164:179]
    v_add_u32_e64 v5, v5, v13
    v_mfma_f32_16x16x32_bf16 v[180:183], v[68:71], v[244:247], v[180:183]
    s_waitcnt vmcnt(1) lgkmcnt(2)
    v_mfma_f32_32x32x16_bf16 v[164:179], v[72:75], v[184:187], v[164:179]
    v_lshl_add_u32 v3, v3, 17, v13
    v_mfma_f32_16x16x32_bf16 v[180:183], v[72:75], v[188:191], v[180:183]
    s_waitcnt vmcnt(0) lgkmcnt(0)
    v_mfma_f32_32x32x16_bf16 v[164:179], v[76:79], v[232:235], v[164:179]
    v_add_u32_e64 v3, s92, v3
    v_mfma_f32_16x16x32_bf16 v[180:183], v[76:79], v[236:239], v[180:183]
    s_mov_b32 s94, 0xbf317218
    s_mov_b32 s95, 0xbf317218
    s_nop 7
    s_nop 1
    v_pk_fma_f32 v[144:145], v[164:165], s[96:97], v[144:145]
    v_pk_fma_f32 v[146:147], v[166:167], s[96:97], v[146:147]
    v_pk_fma_f32 v[148:149], v[168:169], s[96:97], v[148:149]
    v_pk_fma_f32 v[150:151], v[170:171], s[96:97], v[150:151]
    v_pk_fma_f32 v[152:153], v[172:173], s[96:97], v[152:153]
    v_pk_fma_f32 v[154:155], v[174:175], s[96:97], v[154:155]
    v_pk_fma_f32 v[156:157], v[176:177], s[96:97], v[156:157]
    v_pk_fma_f32 v[158:159], v[178:179], s[96:97], v[158:159]
    v_pk_fma_f32 v[160:161], v[180:181], s[96:97], v[160:161]
    v_pk_fma_f32 v[162:163], v[182:183], s[96:97], v[162:163]
    v_exp_f32 v100, v144
    v_exp_f32 v101, v145
    v_exp_f32 v102, v146
    v_exp_f32 v103, v147
    v_exp_f32 v104, v148
    v_exp_f32 v105, v149
    v_exp_f32 v106, v150
    v_exp_f32 v107, v151
    v_exp_f32 v108, v152
    v_exp_f32 v109, v153
    v_exp_f32 v110, v154
    v_exp_f32 v111, v155
    v_exp_f32 v112, v156
    v_exp_f32 v113, v157
    v_exp_f32 v114, v158
    v_exp_f32 v115, v159
    v_exp_f32 v116, v160
    v_exp_f32 v117, v161
    v_exp_f32 v118, v162
    v_exp_f32 v119, v163
    v_pk_add_f32 v[100:101], v[100:101], 1.0 op_sel_hi:[1,0]
    v_pk_add_f32 v[102:103], v[102:103], 1.0 op_sel_hi:[1,0]
    v_pk_add_f32 v[104:105], v[104:105], 1.0 op_sel_hi:[1,0]
    v_pk_add_f32 v[106:107], v[106:107], 1.0 op_sel_hi:[1,0]
    v_pk_add_f32 v[108:109], v[108:109], 1.0 op_sel_hi:[1,0]
    v_pk_add_f32 v[110:111], v[110:111], 1.0 op_sel_hi:[1,0]
    v_pk_add_f32 v[112:113], v[112:113], 1.0 op_sel_hi:[1,0]
    v_pk_add_f32 v[114:115], v[114:115], 1.0 op_sel_hi:[1,0]
    v_pk_add_f32 v[116:117], v[116:117], 1.0 op_sel_hi:[1,0]
    v_pk_add_f32 v[118:119], v[118:119], 1.0 op_sel_hi:[1,0]
    v_rcp_f32 v100, v100
    v_rcp_f32 v101, v101
    v_rcp_f32 v102, v102
    v_rcp_f32 v103, v103
    v_rcp_f32 v104, v104
    v_rcp_f32 v105, v105
    v_rcp_f32 v106, v106
    v_rcp_f32 v107, v107
    v_rcp_f32 v108, v108
    v_rcp_f32 v109, v109
    v_rcp_f32 v110, v110
    v_rcp_f32 v111, v111
    v_rcp_f32 v112, v112
    v_rcp_f32 v113, v113
    v_rcp_f32 v114, v114
    v_rcp_f32 v115, v115
    v_rcp_f32 v116, v116
    v_rcp_f32 v117, v117
    v_rcp_f32 v118, v118
    v_rcp_f32 v119, v119
    v_pk_mul_f32 v[100:101], v[100:101], v[144:145]
    v_pk_mul_f32 v[102:103], v[102:103], v[146:147]
    v_pk_mul_f32 v[104:105], v[104:105], v[148:149]
    v_pk_mul_f32 v[106:107], v[106:107], v[150:151]
    v_pk_mul_f32 v[108:109], v[108:109], v[152:153]
    v_pk_mul_f32 v[110:111], v[110:111], v[154:155]
    v_pk_mul_f32 v[112:113], v[112:113], v[156:157]
    v_pk_mul_f32 v[114:115], v[114:115], v[158:159]
    v_pk_mul_f32 v[116:117], v[116:117], v[160:161]
    v_pk_mul_f32 v[118:119], v[118:119], v[162:163]
    v_pk_fma_f32 v[100:101], v[100:101], s[94:95], v[80:81]
    v_pk_fma_f32 v[102:103], v[102:103], s[94:95], v[82:83]
    v_pk_fma_f32 v[104:105], v[104:105], s[94:95], v[84:85]
    v_pk_fma_f32 v[106:107], v[106:107], s[94:95], v[86:87]
    v_pk_fma_f32 v[108:109], v[108:109], s[94:95], v[88:89]
    v_pk_fma_f32 v[110:111], v[110:111], s[94:95], v[90:91]
    v_pk_fma_f32 v[112:113], v[112:113], s[94:95], v[92:93]
    v_pk_fma_f32 v[114:115], v[114:115], s[94:95], v[94:95]
    v_pk_fma_f32 v[116:117], v[116:117], s[94:95], v[96:97]
    v_pk_fma_f32 v[118:119], v[118:119], s[94:95], v[98:99]
    v_cvt_pk_bf16_f32 v16, v100, v101
    v_cvt_pk_bf16_f32 v17, v102, v103
    ds_write_b64 v2, v[16:17] offset:23040
    v_cvt_pk_bf16_f32 v18, v104, v105
    v_cvt_pk_bf16_f32 v19, v106, v107
    ds_write_b64 v2, v[18:19] offset:23056
    v_cvt_pk_bf16_f32 v20, v108, v109
    v_cvt_pk_bf16_f32 v21, v110, v111
    ds_write_b64 v2, v[20:21] offset:23072
    v_cvt_pk_bf16_f32 v22, v112, v113
    v_cvt_pk_bf16_f32 v23, v114, v115
    ds_write_b64 v2, v[22:23] offset:23088
    v_cvt_pk_bf16_f32 v24, v116, v117
    v_cvt_pk_bf16_f32 v25, v118, v119
    ds_write_b64 v4, v[24:25]
    ds_read_b128 v[32:35], v5 offset:23040
    ds_read_b128 v[36:39], v5 offset:31488
    ds_read_b128 v[40:43], v5 offset:39936
    s_mov_b32 s92, 0
    s_waitcnt lgkmcnt(2)
    buffer_store_dwordx4 v[32:35], v3, s[44:47], s92 offen nt
    s_mov_b32 s92, 2097152
    s_waitcnt lgkmcnt(1)
    buffer_store_dwordx4 v[36:39], v3, s[44:47], s92 offen nt
    s_mov_b32 s92, 4194304
    s_waitcnt lgkmcnt(0)
    buffer_store_dwordx4 v[40:43], v3, s[44:47], s92 offen nt
    s_cmp_ge_u32 s3, 2
    s_cbranch_scc1 K_NOPOS
    v_mul_u32_u24 v4, 21846, v0
    v_lshrrev_b32 v4, 16, v4
    v_mul_u32_u24 v5, 3, v4
    v_sub_u32 v5, v0, v5
    v_lshlrev_b32 v8, 4, v4
    v_lshl_add_u32 v8, v5, 2, v8
    v_add_u32 v5, 1, v5
    v_and_b32 v9, 7, v4
    v_lshl_add_u32 v9, v5, 3, v9
    v_lshrrev_b32 v4, 3, v4
    v_lshlrev_b32 v4, 7, v4
    v_lshrrev_b32_e64 v5, 4, v9
    v_lshl_add_u32 v4, v5, 2, v4
    v_and_b32_e64 v9, 15, v9
    v_lshl_add_u32 v9, v9, 3, v4
    v_add_u32 v9, 103424, v9
    ds_read_b32 v48, v9 offset:0
    ds_read_b32 v49, v9 offset:640
    ds_read_b32 v50, v9 offset:1280
    ds_read_b32 v51, v9 offset:1920
    ds_read_b32 v52, v9 offset:2560
    ds_read_b32 v53, v9 offset:3200
    ds_read_b32 v54, v9 offset:3840
    ds_read_b32 v55, v9 offset:4480
    ds_read_b32 v56, v8 offset:22400
    s_waitcnt lgkmcnt(0)
    v_add_f32 v48, v48, v52
    v_add_f32 v49, v49, v53
    v_add_f32 v50, v50, v54
    v_add_f32 v51, v51, v55
    v_add_f32 v48, v48, v50
    v_add_f32 v49, v49, v51
    v_add_f32 v48, v48, v49
    v_fma_f32 v48, v48, s94, v56
    v_cvt_pk_bf16_f32 v48, v48, v48
    v_cmp_gt_u32 vcc, 120, v0
    s_and_saveexec_b64 s[92:93], vcc
    buffer_store_short v48, v249, s[52:55], 0 offen
    s_mov_b64 exec, -1
K_NOPOS:
K_END:
    s_endpgm
.section .rodata,"a"
.p2align 6
.amdhsa_kernel gather_scatter__cheap_equivariant_egnn__graph_kernel
  .amdhsa_next_free_vgpr 256
  .amdhsa_next_free_sgpr 102
  .amdhsa_accum_offset 256
  .amdhsa_group_segment_fixed_size 0
  .amdhsa_kernarg_size 88
  .amdhsa_user_sgpr_count 2
  .amdhsa_user_sgpr_kernarg_segment_ptr 1
  .amdhsa_system_sgpr_workgroup_id_x 1
  .amdhsa_float_denorm_mode_32 3
.end_amdhsa_kernel
```
